```python
import torch

def _softmax(x, axis=-1):
    return torch.softmax(x, dim=axis)

def _gelu(x):
    return torch.nn.functional.gelu(x, approximate='tanh')

def _silu(x):
    return torch.nn.functional.silu(x)

def _sigmoid(x):
    return torch.sigmoid(x)

def _layernorm(x, axis=-1, eps=1e-05):
    m = x.mean(dim=axis, keepdim=True)
    v = x.var(dim=axis, keepdim=True, unbiased=False)
    return (x - m) / torch.sqrt(v + eps)

def _scatter_add(tgt, idx, src, axis=0):
    return tgt.clone().index_add_(axis, idx, src)

def _segment_sum(src, seg, n):
    out = torch.zeros((n,) + src.shape[1:], dtype=src.dtype)
    return out.index_add_(0, seg, src)

def _pad(x, pw):
    flat = tuple((v for pair in reversed(pw) for v in pair))
    return torch.nn.functional.pad(x, flat)
kernel_name = 'standalone__autoregressive_conv_wavernn__speech'

def setup_inputs():

    _w = lambda a: (lambda t: t.to(torch.bfloat16) if t.is_floating_point() else t)(torch.as_tensor(a))
    B, T, D, K = (2, 4000, 144, 31)
    return {'x': _w((lambda *s: torch.randn(*s, dtype=torch.bfloat16) * 0.1)(B, T, D)), 'w': _w((lambda *s: torch.randn(*s, dtype=torch.bfloat16) * 0.1)(K, D, 2 * D))}

def reference(x, w):
    B, T, D = x.shape
    K = w.shape[0]
    dil = 2
    pad = (K - 1) * dil
    xp = _pad(x, ((0, 0), (pad, 0), (0, 0)))
    h = torch.einsum('btd,de->bte', xp[:, 0:T, :], w[0])
    for i in range(1, K):
        h = h + torch.einsum('btd,de->bte', xp[:, i * dil:i * dil + T, :], w[i])
    f, g = (h[..., :D].clone(), h[..., D:].clone())
    return torch.tanh(f) * _sigmoid(g)
```

```asm
; @launch grid=(252,1,1) block=(256,1,1) lds=158528
.amdgcn_target "amdgcn-amd-amdhsa--gfx950"
.text
.globl standalone__autoregressive_conv_wavernn__speech_kernel
.p2align 8
.type standalone__autoregressive_conv_wavernn__speech_kernel,@function
standalone__autoregressive_conv_wavernn__speech_kernel:
    s_cmp_ge_u32 s2, 252
    s_cbranch_scc1 L_end
    s_load_dwordx8 s[24:31], s[0:1], 0
    s_lshr_b32 s57, s2, 3
    s_getpc_b64 s[48:49]
L_pc:
    v_lshrrev_b32 v248, 6, v0
    v_lshl_add_u32 v175, s57, 2, v248
    v_and_b32 v176, 1, v0
    v_lshl_add_u32 v175, v175, 1, v176
    v_lshlrev_b32 v175, 7, v175
    v_min_u32 v175, L_codeend-L_pc-4, v175
    global_load_dword v243, v175, s[48:49]
    s_memrealtime s[58:59]
    s_and_b32 s34, s2, 7
    s_lshl_b32 s36, s34, 5
    s_add_u32 s36, s36, s57
    s_max_u32 s34, s34, 4
    s_sub_u32 s34, s34, 4
    s_sub_u32 s60, s36, s34
    s_mul_i32 s34, s60, 7282
    s_lshr_b32 s34, s34, 16
    s_cmp_ge_u32 s34, 14
    s_cselect_b32 s36, 14, 0
    s_cselect_b32 s43, 1152000, 0
    s_sub_u32 s37, s34, s36
    v_mul_u32_u24 v246, 1821, v0
    v_lshrrev_b32 v246, 16, v246
    s_mul_i32 s63, s37, 82944
    s_sub_u32 s51, s63, 17280
    v_mul_u32_u24 v247, 36, v246
    v_sub_u32 v247, v0, v247
    v_lshlrev_b32 v247, 4, v247
    v_mul_u32_u24 v246, 7488, v246
    v_min_u32 v246, 42624, v246
    v_add_u32 v204, v246, v247
    v_add3_u32 v200, v204, v246, s51
    v_add_u32 v201, 2304, v200
    v_readfirstlane_b32 s38, v248
    v_and_b32 v255, 63, v0
    s_mul_i32 s35, s34, 9
    s_sub_u32 s35, s60, s35
    s_mul_i32 s50, s35, 11264
    s_add_u32 s50, s50, s51
    v_mul_u32_u24 v174, 22, v248
    v_add_u32 v174, v174, v255
    v_lshl_add_u32 v174, v174, 7, s50
    v_cmp_gt_u32 vcc, 22, v255
    s_nop 1
    v_cndmask_b32 v239, -1, v174, vcc
    s_lshl_b32 s51, s57, 2
    s_add_u32 s51, s51, s38
    s_mul_i32 s51, s51, 10
    v_add_u32 v174, s51, v255
    v_mul_u32_u24 v175, 7282, v174
    v_lshrrev_b32 v175, 20, v175
    v_lshrrev_b32 v176, 2, v175
    v_mul_u32_u24 v176, 995328, v176
    v_mul_u32_u24 v175, 64512, v175
    v_lshlrev_b32 v174, 7, v174
    v_add3_u32 v175, v175, v176, v174
    v_cmp_gt_u32 vcc, 10, v255
    s_nop 1
    v_cndmask_b32 v241, -1, v175, vcc
    s_mov_b32 s10, 2571264
    s_mov_b32 s11, 0x20000
    s_mov_b32 s6, 1152000
    s_mov_b32 s7, 0x20000
    s_waitcnt lgkmcnt(0)
    s_add_u32 s4, s24, s43
    s_addc_u32 s5, s25, 0
    s_mov_b32 s8, s26
    s_mov_b32 s9, s27
    buffer_load_dword v238, v239, s[4:7], 0 offen
    s_mov_b32 s42, 0
    buffer_load_dword v232, v241, s[8:11], s42 offen
    buffer_load_dwordx4 v[0:3], v200, s[4:7], 0 offen offset:0
    buffer_load_dwordx4 v[4:7], v200, s[4:7], 0 offen offset:576
    buffer_load_dwordx4 v[8:11], v200, s[4:7], 0 offen offset:1152
    buffer_load_dwordx4 v[12:15], v200, s[4:7], 0 offen offset:1728
    buffer_load_dwordx4 v[16:19], v201, s[4:7], 0 offen offset:0
    buffer_load_dwordx4 v[20:23], v201, s[4:7], 0 offen offset:576
    buffer_load_dwordx4 v[24:27], v201, s[4:7], 0 offen offset:1152
    buffer_load_dwordx4 v[28:31], v201, s[4:7], 0 offen offset:1728
    buffer_load_dwordx4 v[32:35], v201, s[4:7], 0 offen offset:2304
    s_add_u32 s34, s34, 24
    s_sub_u32 s51, s34, 28
    s_cmp_ge_u32 s34, 28
    s_cselect_b32 s34, s51, s34
    s_load_dwordx2 s[32:33], s[0:1], 32
    s_and_b32 s39, s38, 1
    s_lshr_b32 s40, s38, 1
    v_lshrrev_b32 v174, 1, v255
    v_and_b32 v175, 0x13, v174
    v_and_b32 v176, 4, v174
    v_lshlrev_b32 v176, 1, v176
    v_and_b32 v177, 8, v174
    v_lshrrev_b32 v177, 1, v177
    v_or3_b32 v175, v175, v176, v177
    v_and_b32 v176, 1, v255
    v_lshlrev_b32 v176, 4, v176
    s_mul_i32 s52, s39, 288
    s_lshl_b32 s51, s35, 5
    s_add_u32 s53, s52, s51
    s_mul_i32 s51, s40, 1410048
    s_add_u32 s52, s53, s51
    s_mul_i32 s51, s40, 1244160
    s_add_u32 s53, s53, s51
    s_add_u32 s53, s53, 82944
    v_mul_u32_u24 v177, 576, v175
    v_add3_u32 v188, v177, v176, s52
    v_add3_u32 v189, v177, v176, s53
    s_mov_b32 s10, 2571264
    s_mov_b32 s11, 0x20000
    s_mov_b32 s8, s26
    s_mov_b32 s9, s27
    s_mov_b32 s20, s30
    s_mov_b32 s21, s31
    s_mov_b32 s22, 256
    s_mov_b32 s23, 0x20000
    v_mov_b32 v209, 0
    s_or_b32 s51, s60, s38
    s_cmp_lg_u32 s51, 0
    s_cbranch_scc1 L_nopub
    s_or_b32 s58, s58, 1
    v_mov_b32 v250, s58
    v_mov_b32 v251, s59
    s_mov_b64 exec, 1
    buffer_store_dwordx2 v[250:251], v209, s[20:23], 0 offen sc0 sc1
    s_mov_b64 exec, -1
L_nopub:
    v_add_u32 v202, 6912, v200
    v_add_u32 v203, 11520, v200
    s_mov_b32 s41, 0xffff0000
    s_waitcnt lgkmcnt(0)
    s_mov_b32 s16, s32
    s_mov_b32 s17, s33
    s_mov_b32 s18, 16777216
    s_mov_b32 s19, 0x20000
    s_lshl_b32 s51, s38, 11
    s_add_u32 s51, s51, 150336
    v_lshlrev_b32 v207, 4, v255
    v_add_u32 v192, s51, v207
    v_lshrrev_b32 v178, 5, v255
    v_lshlrev_b32 v174, 9, v178
    v_bfe_u32 v176, v255, 4, 1
    v_lshlrev_b32 v176, 7, v176
    v_and_b32 v177, 15, v255
    v_lshlrev_b32 v177, 3, v177
    v_or3_b32 v193, v174, v176, v177
    v_add_u32 v193, s51, v193
    s_lshl_b32 s51, s35, 2
    s_add_u32 s51, s51, s38
    s_mul_i32 s56, s51, 86016
    s_xor_b32 s51, s51, 2
    s_mul_i32 s53, s51, 86016
    s_add_u32 s51, s34, 4
    s_lshr_b32 s50, s51, 3
    s_mul_i32 s50, s50, 24576
    s_and_b32 s51, s51, 7
    s_lshl_b32 s51, s51, 10
    s_add_u32 s51, s51, s50
    s_sub_u32 s51, s51, 12288
    s_lshl_b32 s50, s34, 10
    s_cmp_lt_u32 s34, 4
    s_cselect_b32 s51, s50, s51
    s_cselect_b32 s50, 12, 13
    s_add_u32 s54, s56, s51
    s_add_u32 s53, s53, s51
    s_lshl_b32 s51, s40, s50
    s_add_u32 s52, s54, s51
    s_add_u32 s53, s53, s51
    s_lshl_b32 s51, 2, s50
    s_add_u32 s54, s54, s51
    s_lshl_b32 s51, s35, 1
    s_add_u32 s51, s51, s39
    s_lshl_b32 s51, s51, 13
    s_add_u32 s37, s51, 4194304
    s_lshl_b32 s51, s40, 5
    s_add_u32 s51, s51, s34
    s_lshl_b32 s51, s51, 7
    s_add_u32 s62, s37, s51
    v_cmp_gt_u32 vcc, 16, v175
    v_mov_b32 v174, 728064
    v_mov_b32 v176, 73728
    v_cndmask_b32 v174, v174, v176, vcc
    s_add_u32 s51, s34, 4
    s_lshr_b32 s50, s51, 3
    s_mul_i32 s50, s50, 18432
    s_and_b32 s61, s51, 7
    s_mul_i32 s61, s61, 165888
    s_add_u32 s61, s61, s50
    s_mul_i32 s50, s34, 165888
    s_cmp_lt_u32 s34, 4
    s_cselect_b32 s61, s50, s61
    s_cselect_b64 vcc, -1, 0
    v_cndmask_b32 v174, 0, v174, vcc
    v_add_u32 v190, v188, v174
    v_add_u32 v191, v189, v174
    v_add_u32 v205, 100224, v204
    v_bfe_u32 v174, v255, 1, 3
    v_and_b32 v175, 1, v255
    v_lshrrev_b32 v176, 4, v255
    v_mul_u32_u24 v177, 5184, v174
    v_mul_u32_u24 v175, 288, v175
    v_lshlrev_b32 v176, 4, v176
    v_add3_u32 v177, v177, v175, v176
    v_mul_u32_u24 v178, 2272, v178
    v_add_u32 v178, 256, v178
    s_mul_i32 s51, s40, 4608
    s_mul_i32 s49, s40, 100224
    v_add_u32 v197, s49, v177
    s_sub_u32 s49, 100224, s49
    s_add_u32 s49, s49, s51
    s_add_u32 s50, s51, 50112
    v_add_u32 v198, s50, v177
    v_add_u32 v194, s51, v197
    v_add_u32 v195, s49, v177
    v_add_u32 v242, v197, v178
    v_add_u32 v196, v198, v178
    v_lshlrev_b32 v208, 7, v255
    v_add_u32 v208, s37, v208
    buffer_load_dwordx4 v[36:39], v201, s[4:7], 0 offen offset:2880
    buffer_load_dwordx4 v[40:43], v201, s[4:7], 0 offen offset:3456
    buffer_load_dwordx4 v[44:47], v201, s[4:7], 0 offen offset:4032
    buffer_load_dwordx4 v[48:51], v202, s[4:7], 0 offen offset:0
    buffer_load_dwordx4 v[52:55], v202, s[4:7], 0 offen offset:576
    buffer_load_dwordx4 v[56:59], v202, s[4:7], 0 offen offset:1152
    buffer_load_dwordx4 v[60:63], v202, s[4:7], 0 offen offset:1728
    buffer_load_dwordx4 v[64:67], v202, s[4:7], 0 offen offset:2304
    s_waitcnt vmcnt(16)
    v_lshlrev_b32 v132, 16, v0
    v_and_b32 v133, s41, v0
    v_lshlrev_b32 v134, 16, v1
    v_and_b32 v135, s41, v1
    v_lshlrev_b32 v136, 16, v2
    v_and_b32 v137, s41, v2
    v_lshlrev_b32 v138, 16, v3
    v_and_b32 v139, s41, v3
    buffer_load_dwordx4 v[68:71], v202, s[4:7], 0 offen offset:2880
    buffer_load_dwordx4 v[72:75], v202, s[4:7], 0 offen offset:3456
    buffer_load_dwordx4 v[76:79], v202, s[4:7], 0 offen offset:4032
    s_waitcnt vmcnt(17)
    v_lshlrev_b32 v148, 16, v4
    v_and_b32 v149, s41, v4
    v_lshlrev_b32 v150, 16, v5
    v_and_b32 v151, s41, v5
    v_lshlrev_b32 v152, 16, v6
    v_and_b32 v153, s41, v6
    v_lshlrev_b32 v154, 16, v7
    v_and_b32 v155, s41, v7
    ds_write_b128 v204, v[4:7] offset:50112
    v_pk_add_f32 v[164:165], v[132:133], v[148:149] neg_lo:[0,1] neg_hi:[0,1]
    v_pk_add_f32 v[166:167], v[134:135], v[150:151] neg_lo:[0,1] neg_hi:[0,1]
    v_pk_add_f32 v[168:169], v[136:137], v[152:153] neg_lo:[0,1] neg_hi:[0,1]
    v_pk_add_f32 v[170:171], v[138:139], v[154:155] neg_lo:[0,1] neg_hi:[0,1]
    v_cvt_pk_bf16_f32 v172, v164, v165
    v_cvt_pk_bf16_f32 v173, v166, v167
    v_cvt_pk_bf16_f32 v174, v168, v169
    v_cvt_pk_bf16_f32 v175, v170, v171
    ds_write_b128 v204, v[172:175] offset:0
    v_lshlrev_b32 v140, 16, v8
    v_and_b32 v141, s41, v8
    v_lshlrev_b32 v142, 16, v9
    v_and_b32 v143, s41, v9
    v_lshlrev_b32 v144, 16, v10
    v_and_b32 v145, s41, v10
    v_lshlrev_b32 v146, 16, v11
    v_and_b32 v147, s41, v11
    v_pk_add_f32 v[164:165], v[140:141], v[148:149] neg_lo:[0,1] neg_hi:[0,1]
    v_pk_add_f32 v[166:167], v[142:143], v[150:151] neg_lo:[0,1] neg_hi:[0,1]
    v_pk_add_f32 v[168:169], v[144:145], v[152:153] neg_lo:[0,1] neg_hi:[0,1]
    v_pk_add_f32 v[170:171], v[146:147], v[154:155] neg_lo:[0,1] neg_hi:[0,1]
    v_cvt_pk_bf16_f32 v176, v164, v165
    v_cvt_pk_bf16_f32 v177, v166, v167
    v_cvt_pk_bf16_f32 v178, v168, v169
    v_cvt_pk_bf16_f32 v179, v170, v171
    ds_write_b128 v205, v[176:179] offset:0
    buffer_load_dwordx4 v[80:83], v203, s[4:7], 0 offen offset:0
    buffer_load_dwordx4 v[84:87], v203, s[4:7], 0 offen offset:576
    buffer_load_dwordx4 v[88:91], v203, s[4:7], 0 offen offset:1152
    s_waitcnt vmcnt(18)
    v_lshlrev_b32 v148, 16, v12
    v_and_b32 v149, s41, v12
    v_lshlrev_b32 v150, 16, v13
    v_and_b32 v151, s41, v13
    v_lshlrev_b32 v152, 16, v14
    v_and_b32 v153, s41, v14
    v_lshlrev_b32 v154, 16, v15
    v_and_b32 v155, s41, v15
    ds_write_b128 v204, v[12:15] offset:50688
    v_pk_add_f32 v[164:165], v[140:141], v[148:149] neg_lo:[0,1] neg_hi:[0,1]
    v_pk_add_f32 v[166:167], v[142:143], v[150:151] neg_lo:[0,1] neg_hi:[0,1]
    v_pk_add_f32 v[168:169], v[144:145], v[152:153] neg_lo:[0,1] neg_hi:[0,1]
    v_pk_add_f32 v[170:171], v[146:147], v[154:155] neg_lo:[0,1] neg_hi:[0,1]
    v_cvt_pk_bf16_f32 v180, v164, v165
    v_cvt_pk_bf16_f32 v181, v166, v167
    v_cvt_pk_bf16_f32 v182, v168, v169
    v_cvt_pk_bf16_f32 v183, v170, v171
    ds_write_b128 v204, v[180:183] offset:576
    v_lshlrev_b32 v132, 16, v16
    v_and_b32 v133, s41, v16
    v_lshlrev_b32 v134, 16, v17
    v_and_b32 v135, s41, v17
    v_lshlrev_b32 v136, 16, v18
    v_and_b32 v137, s41, v18
    v_lshlrev_b32 v138, 16, v19
    v_and_b32 v139, s41, v19
    v_pk_add_f32 v[164:165], v[132:133], v[148:149] neg_lo:[0,1] neg_hi:[0,1]
    v_pk_add_f32 v[166:167], v[134:135], v[150:151] neg_lo:[0,1] neg_hi:[0,1]
    v_pk_add_f32 v[168:169], v[136:137], v[152:153] neg_lo:[0,1] neg_hi:[0,1]
    v_pk_add_f32 v[170:171], v[138:139], v[154:155] neg_lo:[0,1] neg_hi:[0,1]
    v_cvt_pk_bf16_f32 v184, v164, v165
    v_cvt_pk_bf16_f32 v185, v166, v167
    v_cvt_pk_bf16_f32 v186, v168, v169
    v_cvt_pk_bf16_f32 v187, v170, v171
    ds_write_b128 v205, v[184:187] offset:576
    buffer_load_dwordx4 v[92:95], v203, s[4:7], 0 offen offset:1728
    buffer_load_dwordx4 v[96:99], v203, s[4:7], 0 offen offset:2304
    buffer_load_dwordx4 v[100:103], v203, s[4:7], 0 offen offset:2880
    s_waitcnt vmcnt(19)
    v_lshlrev_b32 v148, 16, v20
    v_and_b32 v149, s41, v20
    v_lshlrev_b32 v150, 16, v21
    v_and_b32 v151, s41, v21
    v_lshlrev_b32 v152, 16, v22
    v_and_b32 v153, s41, v22
    v_lshlrev_b32 v154, 16, v23
    v_and_b32 v155, s41, v23
    ds_write_b128 v204, v[20:23] offset:51264
    v_pk_add_f32 v[164:165], v[132:133], v[148:149] neg_lo:[0,1] neg_hi:[0,1]
    v_pk_add_f32 v[166:167], v[134:135], v[150:151] neg_lo:[0,1] neg_hi:[0,1]
    v_pk_add_f32 v[168:169], v[136:137], v[152:153] neg_lo:[0,1] neg_hi:[0,1]
    v_pk_add_f32 v[170:171], v[138:139], v[154:155] neg_lo:[0,1] neg_hi:[0,1]
    v_cvt_pk_bf16_f32 v172, v164, v165
    v_cvt_pk_bf16_f32 v173, v166, v167
    v_cvt_pk_bf16_f32 v174, v168, v169
    v_cvt_pk_bf16_f32 v175, v170, v171
    ds_write_b128 v204, v[172:175] offset:1152
    v_lshlrev_b32 v140, 16, v24
    v_and_b32 v141, s41, v24
    v_lshlrev_b32 v142, 16, v25
    v_and_b32 v143, s41, v25
    v_lshlrev_b32 v144, 16, v26
    v_and_b32 v145, s41, v26
    v_lshlrev_b32 v146, 16, v27
    v_and_b32 v147, s41, v27
    v_pk_add_f32 v[164:165], v[140:141], v[148:149] neg_lo:[0,1] neg_hi:[0,1]
    v_pk_add_f32 v[166:167], v[142:143], v[150:151] neg_lo:[0,1] neg_hi:[0,1]
    v_pk_add_f32 v[168:169], v[144:145], v[152:153] neg_lo:[0,1] neg_hi:[0,1]
    v_pk_add_f32 v[170:171], v[146:147], v[154:155] neg_lo:[0,1] neg_hi:[0,1]
    v_cvt_pk_bf16_f32 v176, v164, v165
    v_cvt_pk_bf16_f32 v177, v166, v167
    v_cvt_pk_bf16_f32 v178, v168, v169
    v_cvt_pk_bf16_f32 v179, v170, v171
    ds_write_b128 v205, v[176:179] offset:1152
    buffer_load_dwordx4 v[104:107], v203, s[4:7], 0 offen offset:3456
    s_waitcnt vmcnt(18)
    v_lshlrev_b32 v148, 16, v28
    v_and_b32 v149, s41, v28
    v_lshlrev_b32 v150, 16, v29
    v_and_b32 v151, s41, v29
    v_lshlrev_b32 v152, 16, v30
    v_and_b32 v153, s41, v30
    v_lshlrev_b32 v154, 16, v31
    v_and_b32 v155, s41, v31
    ds_write_b128 v204, v[28:31] offset:51840
    v_pk_add_f32 v[164:165], v[140:141], v[148:149] neg_lo:[0,1] neg_hi:[0,1]
    v_pk_add_f32 v[166:167], v[142:143], v[150:151] neg_lo:[0,1] neg_hi:[0,1]
    v_pk_add_f32 v[168:169], v[144:145], v[152:153] neg_lo:[0,1] neg_hi:[0,1]
    v_pk_add_f32 v[170:171], v[146:147], v[154:155] neg_lo:[0,1] neg_hi:[0,1]
    v_cvt_pk_bf16_f32 v180, v164, v165
    v_cvt_pk_bf16_f32 v181, v166, v167
    v_cvt_pk_bf16_f32 v182, v168, v169
    v_cvt_pk_bf16_f32 v183, v170, v171
    ds_write_b128 v204, v[180:183] offset:1728
    v_lshlrev_b32 v132, 16, v32
    v_and_b32 v133, s41, v32
    v_lshlrev_b32 v134, 16, v33
    v_and_b32 v135, s41, v33
    v_lshlrev_b32 v136, 16, v34
    v_and_b32 v137, s41, v34
    v_lshlrev_b32 v138, 16, v35
    v_and_b32 v139, s41, v35
    v_pk_add_f32 v[164:165], v[132:133], v[148:149] neg_lo:[0,1] neg_hi:[0,1]
    v_pk_add_f32 v[166:167], v[134:135], v[150:151] neg_lo:[0,1] neg_hi:[0,1]
    v_pk_add_f32 v[168:169], v[136:137], v[152:153] neg_lo:[0,1] neg_hi:[0,1]
    v_pk_add_f32 v[170:171], v[138:139], v[154:155] neg_lo:[0,1] neg_hi:[0,1]
    v_cvt_pk_bf16_f32 v184, v164, v165
    v_cvt_pk_bf16_f32 v185, v166, v167
    v_cvt_pk_bf16_f32 v186, v168, v169
    v_cvt_pk_bf16_f32 v187, v170, v171
    ds_write_b128 v205, v[184:187] offset:1728
    buffer_load_dwordx4 v[210:213], v190, s[8:11], s61 offen
    buffer_load_dwordx4 v[214:217], v191, s[8:11], s61 offen
    s_waitcnt vmcnt(18)
    v_lshlrev_b32 v148, 16, v36
    v_and_b32 v149, s41, v36
    v_lshlrev_b32 v150, 16, v37
    v_and_b32 v151, s41, v37
    v_lshlrev_b32 v152, 16, v38
    v_and_b32 v153, s41, v38
    v_lshlrev_b32 v154, 16, v39
    v_and_b32 v155, s41, v39
    ds_write_b128 v204, v[36:39] offset:52416
    v_pk_add_f32 v[164:165], v[132:133], v[148:149] neg_lo:[0,1] neg_hi:[0,1]
    v_pk_add_f32 v[166:167], v[134:135], v[150:151] neg_lo:[0,1] neg_hi:[0,1]
    v_pk_add_f32 v[168:169], v[136:137], v[152:153] neg_lo:[0,1] neg_hi:[0,1]
    v_pk_add_f32 v[170:171], v[138:139], v[154:155] neg_lo:[0,1] neg_hi:[0,1]
    v_cvt_pk_bf16_f32 v172, v164, v165
    v_cvt_pk_bf16_f32 v173, v166, v167
    v_cvt_pk_bf16_f32 v174, v168, v169
    v_cvt_pk_bf16_f32 v175, v170, v171
    ds_write_b128 v204, v[172:175] offset:2304
    v_lshlrev_b32 v140, 16, v40
    v_and_b32 v141, s41, v40
    v_lshlrev_b32 v142, 16, v41
    v_and_b32 v143, s41, v41
    v_lshlrev_b32 v144, 16, v42
    v_and_b32 v145, s41, v42
    v_lshlrev_b32 v146, 16, v43
    v_and_b32 v147, s41, v43
    v_pk_add_f32 v[164:165], v[140:141], v[148:149] neg_lo:[0,1] neg_hi:[0,1]
    v_pk_add_f32 v[166:167], v[142:143], v[150:151] neg_lo:[0,1] neg_hi:[0,1]
    v_pk_add_f32 v[168:169], v[144:145], v[152:153] neg_lo:[0,1] neg_hi:[0,1]
    v_pk_add_f32 v[170:171], v[146:147], v[154:155] neg_lo:[0,1] neg_hi:[0,1]
    v_cvt_pk_bf16_f32 v176, v164, v165
    v_cvt_pk_bf16_f32 v177, v166, v167
    v_cvt_pk_bf16_f32 v178, v168, v169
    v_cvt_pk_bf16_f32 v179, v170, v171
    ds_write_b128 v205, v[176:179] offset:2304
    s_mov_b32 s42, 331776
    buffer_load_dword v233, v241, s[8:11], s42 offen
    s_mov_b32 s42, 663552
    buffer_load_dword v234, v241, s[8:11], s42 offen
    s_mov_b32 s42, 995328
    buffer_load_dword v235, v241, s[8:11], s42 offen
    s_waitcnt vmcnt(19)
    v_lshlrev_b32 v148, 16, v44
    v_and_b32 v149, s41, v44
    v_lshlrev_b32 v150, 16, v45
    v_and_b32 v151, s41, v45
    v_lshlrev_b32 v152, 16, v46
    v_and_b32 v153, s41, v46
    v_lshlrev_b32 v154, 16, v47
    v_and_b32 v155, s41, v47
    ds_write_b128 v204, v[44:47] offset:52992
    v_pk_add_f32 v[164:165], v[140:141], v[148:149] neg_lo:[0,1] neg_hi:[0,1]
    v_pk_add_f32 v[166:167], v[142:143], v[150:151] neg_lo:[0,1] neg_hi:[0,1]
    v_pk_add_f32 v[168:169], v[144:145], v[152:153] neg_lo:[0,1] neg_hi:[0,1]
    v_pk_add_f32 v[170:171], v[146:147], v[154:155] neg_lo:[0,1] neg_hi:[0,1]
    v_cvt_pk_bf16_f32 v180, v164, v165
    v_cvt_pk_bf16_f32 v181, v166, v167
    v_cvt_pk_bf16_f32 v182, v168, v169
    v_cvt_pk_bf16_f32 v183, v170, v171
    ds_write_b128 v204, v[180:183] offset:2880
    v_lshlrev_b32 v132, 16, v48
    v_and_b32 v133, s41, v48
    v_lshlrev_b32 v134, 16, v49
    v_and_b32 v135, s41, v49
    v_lshlrev_b32 v136, 16, v50
    v_and_b32 v137, s41, v50
    v_lshlrev_b32 v138, 16, v51
    v_and_b32 v139, s41, v51
    v_pk_add_f32 v[164:165], v[132:133], v[148:149] neg_lo:[0,1] neg_hi:[0,1]
    v_pk_add_f32 v[166:167], v[134:135], v[150:151] neg_lo:[0,1] neg_hi:[0,1]
    v_pk_add_f32 v[168:169], v[136:137], v[152:153] neg_lo:[0,1] neg_hi:[0,1]
    v_pk_add_f32 v[170:171], v[138:139], v[154:155] neg_lo:[0,1] neg_hi:[0,1]
    v_cvt_pk_bf16_f32 v184, v164, v165
    v_cvt_pk_bf16_f32 v185, v166, v167
    v_cvt_pk_bf16_f32 v186, v168, v169
    v_cvt_pk_bf16_f32 v187, v170, v171
    ds_write_b128 v205, v[184:187] offset:2880
    s_mov_b32 s42, 0
    buffer_load_dwordx4 a[192:195], v188, s[8:11], s42 offen
    s_waitcnt vmcnt(18)
    v_lshlrev_b32 v148, 16, v52
    v_and_b32 v149, s41, v52
    v_lshlrev_b32 v150, 16, v53
    v_and_b32 v151, s41, v53
    v_lshlrev_b32 v152, 16, v54
    v_and_b32 v153, s41, v54
    v_lshlrev_b32 v154, 16, v55
    v_and_b32 v155, s41, v55
    ds_write_b128 v204, v[52:55] offset:53568
    v_pk_add_f32 v[164:165], v[132:133], v[148:149] neg_lo:[0,1] neg_hi:[0,1]
    v_pk_add_f32 v[166:167], v[134:135], v[150:151] neg_lo:[0,1] neg_hi:[0,1]
    v_pk_add_f32 v[168:169], v[136:137], v[152:153] neg_lo:[0,1] neg_hi:[0,1]
    v_pk_add_f32 v[170:171], v[138:139], v[154:155] neg_lo:[0,1] neg_hi:[0,1]
    v_cvt_pk_bf16_f32 v172, v164, v165
    v_cvt_pk_bf16_f32 v173, v166, v167
    v_cvt_pk_bf16_f32 v174, v168, v169
    v_cvt_pk_bf16_f32 v175, v170, v171
    ds_write_b128 v204, v[172:175] offset:3456
    v_lshlrev_b32 v140, 16, v56
    v_and_b32 v141, s41, v56
    v_lshlrev_b32 v142, 16, v57
    v_and_b32 v143, s41, v57
    v_lshlrev_b32 v144, 16, v58
    v_and_b32 v145, s41, v58
    v_lshlrev_b32 v146, 16, v59
    v_and_b32 v147, s41, v59
    v_pk_add_f32 v[164:165], v[140:141], v[148:149] neg_lo:[0,1] neg_hi:[0,1]
    v_pk_add_f32 v[166:167], v[142:143], v[150:151] neg_lo:[0,1] neg_hi:[0,1]
    v_pk_add_f32 v[168:169], v[144:145], v[152:153] neg_lo:[0,1] neg_hi:[0,1]
    v_pk_add_f32 v[170:171], v[146:147], v[154:155] neg_lo:[0,1] neg_hi:[0,1]
    v_cvt_pk_bf16_f32 v176, v164, v165
    v_cvt_pk_bf16_f32 v177, v166, v167
    v_cvt_pk_bf16_f32 v178, v168, v169
    v_cvt_pk_bf16_f32 v179, v170, v171
    ds_write_b128 v205, v[176:179] offset:3456
    buffer_load_dwordx4 a[196:199], v189, s[8:11], s42 offen
    s_waitcnt vmcnt(17)
    v_lshlrev_b32 v148, 16, v60
    v_and_b32 v149, s41, v60
    v_lshlrev_b32 v150, 16, v61
    v_and_b32 v151, s41, v61
    v_lshlrev_b32 v152, 16, v62
    v_and_b32 v153, s41, v62
    v_lshlrev_b32 v154, 16, v63
    v_and_b32 v155, s41, v63
    ds_write_b128 v204, v[60:63] offset:54144
    v_pk_add_f32 v[164:165], v[140:141], v[148:149] neg_lo:[0,1] neg_hi:[0,1]
    v_pk_add_f32 v[166:167], v[142:143], v[150:151] neg_lo:[0,1] neg_hi:[0,1]
    v_pk_add_f32 v[168:169], v[144:145], v[152:153] neg_lo:[0,1] neg_hi:[0,1]
    v_pk_add_f32 v[170:171], v[146:147], v[154:155] neg_lo:[0,1] neg_hi:[0,1]
    v_cvt_pk_bf16_f32 v180, v164, v165
    v_cvt_pk_bf16_f32 v181, v166, v167
    v_cvt_pk_bf16_f32 v182, v168, v169
    v_cvt_pk_bf16_f32 v183, v170, v171
    ds_write_b128 v204, v[180:183] offset:4032
    v_lshlrev_b32 v132, 16, v64
    v_and_b32 v133, s41, v64
    v_lshlrev_b32 v134, 16, v65
    v_and_b32 v135, s41, v65
    v_lshlrev_b32 v136, 16, v66
    v_and_b32 v137, s41, v66
    v_lshlrev_b32 v138, 16, v67
    v_and_b32 v139, s41, v67
    v_pk_add_f32 v[164:165], v[132:133], v[148:149] neg_lo:[0,1] neg_hi:[0,1]
    v_pk_add_f32 v[166:167], v[134:135], v[150:151] neg_lo:[0,1] neg_hi:[0,1]
    v_pk_add_f32 v[168:169], v[136:137], v[152:153] neg_lo:[0,1] neg_hi:[0,1]
    v_pk_add_f32 v[170:171], v[138:139], v[154:155] neg_lo:[0,1] neg_hi:[0,1]
    v_cvt_pk_bf16_f32 v184, v164, v165
    v_cvt_pk_bf16_f32 v185, v166, v167
    v_cvt_pk_bf16_f32 v186, v168, v169
    v_cvt_pk_bf16_f32 v187, v170, v171
    ds_write_b128 v205, v[184:187] offset:4032
    s_mov_b32 s42, 165888
    buffer_load_dwordx4 a[200:203], v188, s[8:11], s42 offen
    s_load_dwordx2 s[98:99], s[30:31], 0
    s_waitcnt vmcnt(16)
    v_lshlrev_b32 v148, 16, v68
    v_and_b32 v149, s41, v68
    v_lshlrev_b32 v150, 16, v69
    v_and_b32 v151, s41, v69
    v_lshlrev_b32 v152, 16, v70
    v_and_b32 v153, s41, v70
    v_lshlrev_b32 v154, 16, v71
    v_and_b32 v155, s41, v71
    ds_write_b128 v204, v[68:71] offset:54720
    v_pk_add_f32 v[164:165], v[132:133], v[148:149] neg_lo:[0,1] neg_hi:[0,1]
    v_pk_add_f32 v[166:167], v[134:135], v[150:151] neg_lo:[0,1] neg_hi:[0,1]
    v_pk_add_f32 v[168:169], v[136:137], v[152:153] neg_lo:[0,1] neg_hi:[0,1]
    v_pk_add_f32 v[170:171], v[138:139], v[154:155] neg_lo:[0,1] neg_hi:[0,1]
    v_cvt_pk_bf16_f32 v172, v164, v165
    v_cvt_pk_bf16_f32 v173, v166, v167
    v_cvt_pk_bf16_f32 v174, v168, v169
    v_cvt_pk_bf16_f32 v175, v170, v171
    ds_write_b128 v204, v[172:175] offset:4608
    v_lshlrev_b32 v140, 16, v72
    v_and_b32 v141, s41, v72
    v_lshlrev_b32 v142, 16, v73
    v_and_b32 v143, s41, v73
    v_lshlrev_b32 v144, 16, v74
    v_and_b32 v145, s41, v74
    v_lshlrev_b32 v146, 16, v75
    v_and_b32 v147, s41, v75
    v_pk_add_f32 v[164:165], v[140:141], v[148:149] neg_lo:[0,1] neg_hi:[0,1]
    v_pk_add_f32 v[166:167], v[142:143], v[150:151] neg_lo:[0,1] neg_hi:[0,1]
    v_pk_add_f32 v[168:169], v[144:145], v[152:153] neg_lo:[0,1] neg_hi:[0,1]
    v_pk_add_f32 v[170:171], v[146:147], v[154:155] neg_lo:[0,1] neg_hi:[0,1]
    v_cvt_pk_bf16_f32 v176, v164, v165
    v_cvt_pk_bf16_f32 v177, v166, v167
    v_cvt_pk_bf16_f32 v178, v168, v169
    v_cvt_pk_bf16_f32 v179, v170, v171
    ds_write_b128 v205, v[176:179] offset:4608
    buffer_load_dwordx4 a[204:207], v189, s[8:11], s42 offen
    s_waitcnt vmcnt(15)
    v_lshlrev_b32 v148, 16, v76
    v_and_b32 v149, s41, v76
    v_lshlrev_b32 v150, 16, v77
    v_and_b32 v151, s41, v77
    v_lshlrev_b32 v152, 16, v78
    v_and_b32 v153, s41, v78
    v_lshlrev_b32 v154, 16, v79
    v_and_b32 v155, s41, v79
    ds_write_b128 v204, v[76:79] offset:55296
    v_pk_add_f32 v[164:165], v[140:141], v[148:149] neg_lo:[0,1] neg_hi:[0,1]
    v_pk_add_f32 v[166:167], v[142:143], v[150:151] neg_lo:[0,1] neg_hi:[0,1]
    v_pk_add_f32 v[168:169], v[144:145], v[152:153] neg_lo:[0,1] neg_hi:[0,1]
    v_pk_add_f32 v[170:171], v[146:147], v[154:155] neg_lo:[0,1] neg_hi:[0,1]
    v_cvt_pk_bf16_f32 v180, v164, v165
    v_cvt_pk_bf16_f32 v181, v166, v167
    v_cvt_pk_bf16_f32 v182, v168, v169
    v_cvt_pk_bf16_f32 v183, v170, v171
    ds_write_b128 v204, v[180:183] offset:5184
    v_lshlrev_b32 v132, 16, v80
    v_and_b32 v133, s41, v80
    v_lshlrev_b32 v134, 16, v81
    v_and_b32 v135, s41, v81
    v_lshlrev_b32 v136, 16, v82
    v_and_b32 v137, s41, v82
    v_lshlrev_b32 v138, 16, v83
    v_and_b32 v139, s41, v83
    v_pk_add_f32 v[164:165], v[132:133], v[148:149] neg_lo:[0,1] neg_hi:[0,1]
    v_pk_add_f32 v[166:167], v[134:135], v[150:151] neg_lo:[0,1] neg_hi:[0,1]
    v_pk_add_f32 v[168:169], v[136:137], v[152:153] neg_lo:[0,1] neg_hi:[0,1]
    v_pk_add_f32 v[170:171], v[138:139], v[154:155] neg_lo:[0,1] neg_hi:[0,1]
    v_cvt_pk_bf16_f32 v184, v164, v165
    v_cvt_pk_bf16_f32 v185, v166, v167
    v_cvt_pk_bf16_f32 v186, v168, v169
    v_cvt_pk_bf16_f32 v187, v170, v171
    ds_write_b128 v205, v[184:187] offset:5184
    s_mov_b32 s42, 331776
    buffer_load_dwordx4 a[208:211], v188, s[8:11], s42 offen
    s_waitcnt vmcnt(14)
    v_lshlrev_b32 v148, 16, v84
    v_and_b32 v149, s41, v84
    v_lshlrev_b32 v150, 16, v85
    v_and_b32 v151, s41, v85
    v_lshlrev_b32 v152, 16, v86
    v_and_b32 v153, s41, v86
    v_lshlrev_b32 v154, 16, v87
    v_and_b32 v155, s41, v87
    ds_write_b128 v204, v[84:87] offset:55872
    v_pk_add_f32 v[164:165], v[132:133], v[148:149] neg_lo:[0,1] neg_hi:[0,1]
    v_pk_add_f32 v[166:167], v[134:135], v[150:151] neg_lo:[0,1] neg_hi:[0,1]
    v_pk_add_f32 v[168:169], v[136:137], v[152:153] neg_lo:[0,1] neg_hi:[0,1]
    v_pk_add_f32 v[170:171], v[138:139], v[154:155] neg_lo:[0,1] neg_hi:[0,1]
    v_cvt_pk_bf16_f32 v172, v164, v165
    v_cvt_pk_bf16_f32 v173, v166, v167
    v_cvt_pk_bf16_f32 v174, v168, v169
    v_cvt_pk_bf16_f32 v175, v170, v171
    ds_write_b128 v204, v[172:175] offset:5760
    v_lshlrev_b32 v140, 16, v88
    v_and_b32 v141, s41, v88
    v_lshlrev_b32 v142, 16, v89
    v_and_b32 v143, s41, v89
    v_lshlrev_b32 v144, 16, v90
    v_and_b32 v145, s41, v90
    v_lshlrev_b32 v146, 16, v91
    v_and_b32 v147, s41, v91
    v_pk_add_f32 v[164:165], v[140:141], v[148:149] neg_lo:[0,1] neg_hi:[0,1]
    v_pk_add_f32 v[166:167], v[142:143], v[150:151] neg_lo:[0,1] neg_hi:[0,1]
    v_pk_add_f32 v[168:169], v[144:145], v[152:153] neg_lo:[0,1] neg_hi:[0,1]
    v_pk_add_f32 v[170:171], v[146:147], v[154:155] neg_lo:[0,1] neg_hi:[0,1]
    v_cvt_pk_bf16_f32 v176, v164, v165
    v_cvt_pk_bf16_f32 v177, v166, v167
    v_cvt_pk_bf16_f32 v178, v168, v169
    v_cvt_pk_bf16_f32 v179, v170, v171
    ds_write_b128 v205, v[176:179] offset:5760
    s_waitcnt vmcnt(8)
    s_memrealtime s[58:59]
    ds_write_b128 v192, v[210:213] offset:0
    ds_write_b128 v192, v[214:217] offset:1024
    ds_read_b64_tr_b16 v[218:219], v193 offset:0
    ds_read_b64_tr_b16 v[220:221], v193 offset:256
    ds_read_b64_tr_b16 v[222:223], v193 offset:1024
    ds_read_b64_tr_b16 v[224:225], v193 offset:1280
    v_lshlrev_b32 v148, 16, v92
    v_and_b32 v149, s41, v92
    v_lshlrev_b32 v150, 16, v93
    v_and_b32 v151, s41, v93
    v_lshlrev_b32 v152, 16, v94
    v_and_b32 v153, s41, v94
    v_lshlrev_b32 v154, 16, v95
    v_and_b32 v155, s41, v95
    ds_write_b128 v204, v[92:95] offset:56448
    v_pk_add_f32 v[164:165], v[140:141], v[148:149] neg_lo:[0,1] neg_hi:[0,1]
    v_pk_add_f32 v[166:167], v[142:143], v[150:151] neg_lo:[0,1] neg_hi:[0,1]
    v_pk_add_f32 v[168:169], v[144:145], v[152:153] neg_lo:[0,1] neg_hi:[0,1]
    v_pk_add_f32 v[170:171], v[146:147], v[154:155] neg_lo:[0,1] neg_hi:[0,1]
    v_cvt_pk_bf16_f32 v180, v164, v165
    v_cvt_pk_bf16_f32 v181, v166, v167
    v_cvt_pk_bf16_f32 v182, v168, v169
    v_cvt_pk_bf16_f32 v183, v170, v171
    ds_write_b128 v204, v[180:183] offset:6336
    v_lshlrev_b32 v132, 16, v96
    v_and_b32 v133, s41, v96
    v_lshlrev_b32 v134, 16, v97
    v_and_b32 v135, s41, v97
    v_lshlrev_b32 v136, 16, v98
    v_and_b32 v137, s41, v98
    v_lshlrev_b32 v138, 16, v99
    v_and_b32 v139, s41, v99
    v_pk_add_f32 v[164:165], v[132:133], v[148:149] neg_lo:[0,1] neg_hi:[0,1]
    v_pk_add_f32 v[166:167], v[134:135], v[150:151] neg_lo:[0,1] neg_hi:[0,1]
    v_pk_add_f32 v[168:169], v[136:137], v[152:153] neg_lo:[0,1] neg_hi:[0,1]
    v_pk_add_f32 v[170:171], v[138:139], v[154:155] neg_lo:[0,1] neg_hi:[0,1]
    v_cvt_pk_bf16_f32 v184, v164, v165
    v_cvt_pk_bf16_f32 v185, v166, v167
    v_cvt_pk_bf16_f32 v186, v168, v169
    v_cvt_pk_bf16_f32 v187, v170, v171
    ds_write_b128 v205, v[184:187] offset:6336
    s_waitcnt lgkmcnt(0)
    v_lshlrev_b32 v156, 16, v218
    v_lshlrev_b32 v157, 16, v222
    v_and_b32 v158, s41, v218
    v_and_b32 v159, s41, v222
    v_add_f32 v156, v156, v157
    v_add_f32 v158, v158, v159
    v_cvt_pk_bf16_f32 v226, v156, v158
    v_lshlrev_b32 v160, 16, v219
    v_lshlrev_b32 v161, 16, v223
    v_and_b32 v162, s41, v219
    v_and_b32 v163, s41, v223
    v_add_f32 v160, v160, v161
    v_add_f32 v162, v162, v163
    v_cvt_pk_bf16_f32 v227, v160, v162
    v_lshlrev_b32 v156, 16, v220
    v_lshlrev_b32 v157, 16, v224
    v_and_b32 v158, s41, v220
    v_and_b32 v159, s41, v224
    v_add_f32 v156, v156, v157
    v_add_f32 v158, v158, v159
    v_cvt_pk_bf16_f32 v228, v156, v158
    v_lshlrev_b32 v160, 16, v221
    v_lshlrev_b32 v161, 16, v225
    v_and_b32 v162, s41, v221
    v_and_b32 v163, s41, v225
    v_add_f32 v160, v160, v161
    v_add_f32 v162, v162, v163
    v_cvt_pk_bf16_f32 v229, v160, v162
    v_mov_b32 v244, s58
    v_mov_b32 v245, s59
    buffer_store_dwordx4 v[218:221], v207, s[16:19], s52 offen sc1
    buffer_store_dwordx4 v[222:225], v207, s[16:19], s53 offen sc1
    buffer_store_dwordx4 v[226:229], v207, s[16:19], s54 offen sc1
    s_waitcnt vmcnt(6)
    ds_write_b128 v192, a[192:195] offset:0
    ds_write_b128 v192, a[196:199] offset:1024
    ds_read_b64_tr_b16 v[108:109], v193 offset:0
    ds_read_b64_tr_b16 v[110:111], v193 offset:256
    ds_read_b64_tr_b16 v[112:113], v193 offset:1024
    ds_read_b64_tr_b16 v[114:115], v193 offset:1280
    v_lshlrev_b32 v148, 16, v100
    v_and_b32 v149, s41, v100
    v_lshlrev_b32 v150, 16, v101
    v_and_b32 v151, s41, v101
    v_lshlrev_b32 v152, 16, v102
    v_and_b32 v153, s41, v102
    v_lshlrev_b32 v154, 16, v103
    v_and_b32 v155, s41, v103
    ds_write_b128 v204, v[100:103] offset:57024
    v_pk_add_f32 v[164:165], v[132:133], v[148:149] neg_lo:[0,1] neg_hi:[0,1]
    v_pk_add_f32 v[166:167], v[134:135], v[150:151] neg_lo:[0,1] neg_hi:[0,1]
    v_pk_add_f32 v[168:169], v[136:137], v[152:153] neg_lo:[0,1] neg_hi:[0,1]
    v_pk_add_f32 v[170:171], v[138:139], v[154:155] neg_lo:[0,1] neg_hi:[0,1]
    v_cvt_pk_bf16_f32 v172, v164, v165
    v_cvt_pk_bf16_f32 v173, v166, v167
    v_cvt_pk_bf16_f32 v174, v168, v169
    v_cvt_pk_bf16_f32 v175, v170, v171
    ds_write_b128 v204, v[172:175] offset:6912
    v_lshlrev_b32 v140, 16, v104
    v_and_b32 v141, s41, v104
    v_lshlrev_b32 v142, 16, v105
    v_and_b32 v143, s41, v105
    v_lshlrev_b32 v144, 16, v106
    v_and_b32 v145, s41, v106
    v_lshlrev_b32 v146, 16, v107
    v_and_b32 v147, s41, v107
    v_pk_add_f32 v[164:165], v[140:141], v[148:149] neg_lo:[0,1] neg_hi:[0,1]
    v_pk_add_f32 v[166:167], v[142:143], v[150:151] neg_lo:[0,1] neg_hi:[0,1]
    v_pk_add_f32 v[168:169], v[144:145], v[152:153] neg_lo:[0,1] neg_hi:[0,1]
    v_pk_add_f32 v[170:171], v[146:147], v[154:155] neg_lo:[0,1] neg_hi:[0,1]
    v_cvt_pk_bf16_f32 v176, v164, v165
    v_cvt_pk_bf16_f32 v177, v166, v167
    v_cvt_pk_bf16_f32 v178, v168, v169
    v_cvt_pk_bf16_f32 v179, v170, v171
    ds_write_b128 v205, v[176:179] offset:6912
    s_waitcnt lgkmcnt(3)
    v_lshlrev_b32 v156, 16, v108
    v_lshlrev_b32 v157, 16, v112
    v_and_b32 v158, s41, v108
    v_and_b32 v159, s41, v112
    v_add_f32 v156, v156, v157
    v_add_f32 v158, v158, v159
    v_cvt_pk_bf16_f32 v116, v156, v158
    v_lshlrev_b32 v160, 16, v109
    v_lshlrev_b32 v161, 16, v113
    v_and_b32 v162, s41, v109
    v_and_b32 v163, s41, v113
    v_add_f32 v160, v160, v161
    v_add_f32 v162, v162, v163
    v_cvt_pk_bf16_f32 v117, v160, v162
    v_lshlrev_b32 v156, 16, v110
    v_lshlrev_b32 v157, 16, v114
    v_and_b32 v158, s41, v110
    v_and_b32 v159, s41, v114
    v_add_f32 v156, v156, v157
    v_add_f32 v158, v158, v159
    v_cvt_pk_bf16_f32 v118, v156, v158
    v_lshlrev_b32 v160, 16, v111
    v_lshlrev_b32 v161, 16, v115
    v_and_b32 v162, s41, v111
    v_and_b32 v163, s41, v115
    v_add_f32 v160, v160, v161
    v_add_f32 v162, v162, v163
    v_cvt_pk_bf16_f32 v119, v160, v162
    s_waitcnt lgkmcnt(0)
    s_waitcnt lgkmcnt(0)
    s_cmp_eq_u64 s[98:99], 0
    s_cbranch_scc1 L_nspin
    s_sub_u32 s100, s58, s98
    s_subb_u32 s101, s59, s99
    s_cbranch_scc1 L_restamp
    s_min_u32 s101, s101, 1
    s_lshl_b32 s101, s101, 31
    s_or_b32 s100, s100, s101
    s_cmp_ge_u32 s100, 1200
    s_cbranch_scc1 L_nspin
L_rback:
    v_mov_b32 v244, s98
    v_mov_b32 v245, s99
    s_add_u32 s100, s98, 0x1000000
    s_addc_u32 s101, s99, 0
    s_barrier
    ds_read_b128 a[0:3], v194 offset:0
    ds_read_b128 a[4:7], v194 offset:576
    ds_read_b128 a[8:11], v194 offset:1152
    ds_read_b128 a[12:15], v194 offset:1728
    ds_read_b128 a[16:19], v194 offset:2304
    ds_read_b128 a[20:23], v194 offset:2880
    ds_read_b128 a[24:27], v194 offset:3456
    ds_read_b128 a[28:31], v194 offset:4032
    ds_read_b128 a[32:35], v194 offset:4608
    s_waitcnt lgkmcnt(8)
    v_mfma_f32_16x16x32_bf16 v[0:3], v[108:111], a[0:3], 0
    buffer_load_dwordx4 a[212:215], v189, s[8:11], s42 offen
    ds_read_b128 a[64:67], v195 offset:0
    s_waitcnt lgkmcnt(8)
    v_mfma_f32_16x16x32_bf16 v[4:7], v[108:111], a[4:7], 0
    ds_read_b128 a[68:71], v195 offset:576
    ds_read_b128 a[72:75], v195 offset:1152
    s_waitcnt lgkmcnt(9)
    v_mfma_f32_16x16x32_bf16 v[8:11], v[108:111], a[8:11], 0
    ds_read_b128 a[76:79], v195 offset:1728
    ds_read_b128 a[80:83], v195 offset:2304
    s_waitcnt lgkmcnt(10)
    v_mfma_f32_16x16x32_bf16 v[12:15], v[108:111], a[12:15], 0
    ds_read_b128 a[84:87], v195 offset:2880
    ds_read_b128 a[88:91], v195 offset:3456
    s_waitcnt lgkmcnt(11)
    v_mfma_f32_16x16x32_bf16 v[16:19], v[108:111], a[16:19], 0
    ds_read_b128 a[92:95], v195 offset:4032
    ds_read_b128 a[160:163], v195 offset:4608
    s_waitcnt lgkmcnt(12)
    v_mfma_f32_16x16x32_bf16 v[20:23], v[108:111], a[20:23], 0
    ds_read_b128 a[96:99], v198 offset:0
    ds_read_b128 a[100:103], v198 offset:576
    s_waitcnt lgkmcnt(13)
    v_mfma_f32_16x16x32_bf16 v[24:27], v[108:111], a[24:27], 0
    ds_read_b128 a[104:107], v198 offset:1152
    ds_read_b128 a[108:111], v198 offset:1728
    s_waitcnt lgkmcnt(14)
    v_mfma_f32_16x16x32_bf16 v[28:31], v[108:111], a[28:31], 0
    s_waitcnt vmcnt(5)
    ds_write_b128 v192, a[200:203] offset:0
    s_waitcnt lgkmcnt(14)
    v_mfma_f32_16x16x32_bf16 v[32:35], v[108:111], a[32:35], 0
    ds_write_b128 v192, a[204:207] offset:1024
    s_waitcnt lgkmcnt(14)
    v_mfma_f32_16x16x32_bf16 v[36:39], v[112:115], a[64:67], 0
    ds_read_b64_tr_b16 v[120:121], v193 offset:0
    ds_read_b64_tr_b16 v[122:123], v193 offset:256
    s_waitcnt lgkmcnt(15)
    v_mfma_f32_16x16x32_bf16 v[40:43], v[112:115], a[68:71], 0
    ds_read_b64_tr_b16 v[124:125], v193 offset:1024
    ds_read_b64_tr_b16 v[126:127], v193 offset:1280
    s_waitcnt lgkmcnt(15)
    v_mfma_f32_16x16x32_bf16 v[44:47], v[112:115], a[72:75], 0
    s_mov_b32 s42, 497664
    buffer_load_dwordx4 a[216:219], v188, s[8:11], s42 offen
    v_mfma_f32_16x16x32_bf16 v[48:51], v[112:115], a[76:79], 0
    buffer_load_dwordx4 a[220:223], v189, s[8:11], s42 offen
    ds_read_b128 a[112:115], v198 offset:2304
    s_waitcnt lgkmcnt(15)
    v_mfma_f32_16x16x32_bf16 v[52:55], v[112:115], a[80:83], 0
    ds_read_b128 a[116:119], v198 offset:2880
    ds_read_b128 a[120:123], v198 offset:3456
    s_waitcnt lgkmcnt(15)
    v_mfma_f32_16x16x32_bf16 v[56:59], v[112:115], a[84:87], 0
    ds_read_b128 a[124:127], v198 offset:4032
    ds_read_b128 a[128:131], v198 offset:4608
    v_mfma_f32_16x16x32_bf16 v[60:63], v[112:115], a[88:91], 0
    ds_read_b128 a[36:39], v194 offset:5184
    ds_read_b128 a[164:167], v195 offset:5184
    s_waitcnt lgkmcnt(15)
    v_mfma_f32_16x16x32_bf16 v[64:67], v[112:115], a[92:95], 0
    ds_read_b128 a[132:135], v198 offset:5184
    ds_read_b128 a[40:43], v194 offset:5760
    v_mfma_f32_16x16x32_bf16 v[68:71], v[112:115], a[160:163], 0
    ds_read_b128 a[168:171], v195 offset:5760
    ds_read_b128 a[136:139], v198 offset:5760
    v_mfma_f32_16x16x32_bf16 v[72:75], v[116:119], a[96:99], 0
    ds_read_b128 a[44:47], v194 offset:6336
    ds_read_b128 a[172:175], v195 offset:6336
    v_mfma_f32_16x16x32_bf16 v[76:79], v[116:119], a[100:103], 0
    ds_read_b128 a[140:143], v198 offset:6336
    ds_read_b128 a[48:51], v194 offset:6912
    s_waitcnt lgkmcnt(15)
    v_mfma_f32_16x16x32_bf16 v[80:83], v[116:119], a[104:107], 0
    ds_read_b128 a[176:179], v195 offset:6912
    v_lshlrev_b32 v156, 16, v120
    v_mfma_f32_16x16x32_bf16 v[84:87], v[116:119], a[108:111], 0
    v_lshlrev_b32 v157, 16, v124
    v_and_b32 v158, s41, v120
    s_waitcnt lgkmcnt(15)
    v_mfma_f32_16x16x32_bf16 v[88:91], v[116:119], a[112:115], 0
    ds_read_b128 a[144:147], v198 offset:6912
    v_and_b32 v159, s41, v124
    s_waitcnt lgkmcnt(15)
    v_mfma_f32_16x16x32_bf16 v[92:95], v[116:119], a[116:119], 0
    v_add_f32 v156, v156, v157
    v_add_f32 v158, v158, v159
    s_waitcnt lgkmcnt(14)
    v_mfma_f32_16x16x32_bf16 v[96:99], v[116:119], a[120:123], 0
    ds_read_b128 a[52:55], v194 offset:7488
    v_cvt_pk_bf16_f32 v128, v156, v158
    s_waitcnt lgkmcnt(14)
    v_mfma_f32_16x16x32_bf16 v[100:103], v[116:119], a[124:127], 0
    v_lshlrev_b32 v160, 16, v121
    v_lshlrev_b32 v161, 16, v125
    s_waitcnt lgkmcnt(13)
    v_mfma_f32_16x16x32_bf16 v[104:107], v[116:119], a[128:131], 0
    ds_read_b128 a[180:183], v195 offset:7488
    v_and_b32 v162, s41, v121
    v_mfma_f32_16x16x32_bf16 v[0:3], v[120:123], a[4:7], v[0:3]
    v_and_b32 v163, s41, v125
    v_add_f32 v160, v160, v161
    v_mfma_f32_16x16x32_bf16 v[4:7], v[120:123], a[8:11], v[4:7]
    ds_read_b128 a[148:151], v198 offset:7488
    v_add_f32 v162, v162, v163
    v_mfma_f32_16x16x32_bf16 v[8:11], v[120:123], a[12:15], v[8:11]
    v_cvt_pk_bf16_f32 v129, v160, v162
    v_lshlrev_b32 v156, 16, v122
    v_mfma_f32_16x16x32_bf16 v[12:15], v[120:123], a[16:19], v[12:15]
    ds_read_b128 a[56:59], v194 offset:8064
    v_lshlrev_b32 v157, 16, v126
    v_mfma_f32_16x16x32_bf16 v[16:19], v[120:123], a[20:23], v[16:19]
    v_and_b32 v158, s41, v122
    v_and_b32 v159, s41, v126
    v_mfma_f32_16x16x32_bf16 v[20:23], v[120:123], a[24:27], v[20:23]
    ds_read_b128 a[184:187], v195 offset:8064
    v_add_f32 v156, v156, v157
    v_mfma_f32_16x16x32_bf16 v[24:27], v[120:123], a[28:31], v[24:27]
    v_add_f32 v158, v158, v159
    v_cvt_pk_bf16_f32 v130, v156, v158
    v_mfma_f32_16x16x32_bf16 v[28:31], v[120:123], a[32:35], v[28:31]
    s_waitcnt vmcnt(2) lgkmcnt(13)
    ds_write_b128 v192, a[208:211] offset:0
    v_mfma_f32_16x16x32_bf16 v[32:35], v[120:123], a[36:39], v[32:35]
    ds_write_b128 v192, a[212:215] offset:1024
    v_mfma_f32_16x16x32_bf16 v[36:39], v[124:127], a[68:71], v[36:39]
    ds_read_b64_tr_b16 v[132:133], v193 offset:0
    ds_read_b64_tr_b16 v[134:135], v193 offset:256
    v_mfma_f32_16x16x32_bf16 v[40:43], v[124:127], a[72:75], v[40:43]
    ds_read_b64_tr_b16 v[136:137], v193 offset:1024
    ds_read_b64_tr_b16 v[138:139], v193 offset:1280
    v_mfma_f32_16x16x32_bf16 v[44:47], v[124:127], a[76:79], v[44:47]
    s_mov_b64 exec, 1
    buffer_store_dwordx2 v[244:245], v209, s[16:19], s62 offen sc1
    s_mov_b64 exec, -1
    s_mov_b32 s42, 663552
    buffer_load_dwordx4 a[224:227], v188, s[8:11], s42 offen
    v_mfma_f32_16x16x32_bf16 v[48:51], v[124:127], a[80:83], v[48:51]
    buffer_load_dwordx4 a[228:231], v189, s[8:11], s42 offen
    ds_read_b128 a[152:155], v198 offset:8064
    v_mfma_f32_16x16x32_bf16 v[52:55], v[124:127], a[84:87], v[52:55]
    ds_read_b128 a[156:159], v198 offset:8640
    ds_read_b128 a[188:191], v195 offset:8640
    v_mfma_f32_16x16x32_bf16 v[56:59], v[124:127], a[88:91], v[56:59]
    ds_read_b128 a[60:63], v194 offset:8640
    v_lshlrev_b32 v160, 16, v123
    v_mfma_f32_16x16x32_bf16 v[60:63], v[124:127], a[92:95], v[60:63]
    ds_read_b128 a[96:99], v196 offset:0
    v_lshlrev_b32 v161, 16, v127
    v_mfma_f32_16x16x32_bf16 v[64:67], v[124:127], a[160:163], v[64:67]
    v_and_b32 v162, s41, v123
    v_and_b32 v163, s41, v127
    v_mfma_f32_16x16x32_bf16 v[68:71], v[124:127], a[164:167], v[68:71]
    v_add_f32 v160, v160, v161
    v_add_f32 v162, v162, v163
    v_cvt_pk_bf16_f32 v131, v160, v162
    s_nop 1
    v_mfma_f32_16x16x32_bf16 v[72:75], v[128:131], a[100:103], v[72:75]
    ds_read_b128 a[100:103], v196 offset:576
    s_waitcnt lgkmcnt(6)
    v_lshlrev_b32 v156, 16, v132
    v_mfma_f32_16x16x32_bf16 v[76:79], v[128:131], a[104:107], v[76:79]
    v_lshlrev_b32 v157, 16, v136
    v_and_b32 v158, s41, v132
    v_mfma_f32_16x16x32_bf16 v[80:83], v[128:131], a[108:111], v[80:83]
    v_and_b32 v159, s41, v136
    v_add_f32 v156, v156, v157
    v_mfma_f32_16x16x32_bf16 v[84:87], v[128:131], a[112:115], v[84:87]
    v_add_f32 v158, v158, v159
    v_cvt_pk_bf16_f32 v140, v156, v158
    v_mfma_f32_16x16x32_bf16 v[88:91], v[128:131], a[116:119], v[88:91]
    v_lshlrev_b32 v160, 16, v133
    v_lshlrev_b32 v161, 16, v137
    v_mfma_f32_16x16x32_bf16 v[92:95], v[128:131], a[120:123], v[92:95]
    v_and_b32 v162, s41, v133
    v_mfma_f32_16x16x32_bf16 v[96:99], v[128:131], a[124:127], v[96:99]
    v_and_b32 v163, s41, v137
    v_add_f32 v160, v160, v161
    v_mfma_f32_16x16x32_bf16 v[100:103], v[128:131], a[128:131], v[100:103]
    v_add_f32 v162, v162, v163
    v_cvt_pk_bf16_f32 v141, v160, v162
    v_mfma_f32_16x16x32_bf16 v[104:107], v[128:131], a[132:135], v[104:107]
    v_lshlrev_b32 v156, 16, v134
    v_lshlrev_b32 v157, 16, v138
    v_mfma_f32_16x16x32_bf16 v[0:3], v[132:135], a[8:11], v[0:3]
    v_and_b32 v158, s41, v134
    v_and_b32 v159, s41, v138
    v_mfma_f32_16x16x32_bf16 v[4:7], v[132:135], a[12:15], v[4:7]
    v_add_f32 v156, v156, v157
    v_add_f32 v158, v158, v159
    v_mfma_f32_16x16x32_bf16 v[8:11], v[132:135], a[16:19], v[8:11]
    v_cvt_pk_bf16_f32 v142, v156, v158
    v_lshlrev_b32 v160, 16, v135
    v_mfma_f32_16x16x32_bf16 v[12:15], v[132:135], a[20:23], v[12:15]
    v_lshlrev_b32 v161, 16, v139
    v_and_b32 v162, s41, v135
    v_mfma_f32_16x16x32_bf16 v[16:19], v[132:135], a[24:27], v[16:19]
    v_and_b32 v163, s41, v139
    v_add_f32 v160, v160, v161
    v_mfma_f32_16x16x32_bf16 v[20:23], v[132:135], a[28:31], v[20:23]
    v_add_f32 v162, v162, v163
    v_cvt_pk_bf16_f32 v143, v160, v162
    v_mfma_f32_16x16x32_bf16 v[24:27], v[132:135], a[32:35], v[24:27]
    v_mfma_f32_16x16x32_bf16 v[28:31], v[132:135], a[36:39], v[28:31]
    s_waitcnt vmcnt(3) lgkmcnt(1)
    ds_write_b128 v192, a[216:219] offset:0
    v_mfma_f32_16x16x32_bf16 v[32:35], v[132:135], a[40:43], v[32:35]
    ds_write_b128 v192, a[220:223] offset:1024
    v_mfma_f32_16x16x32_bf16 v[36:39], v[136:139], a[72:75], v[36:39]
    ds_read_b64_tr_b16 v[144:145], v193 offset:0
    ds_read_b64_tr_b16 v[146:147], v193 offset:256
    v_mfma_f32_16x16x32_bf16 v[40:43], v[136:139], a[76:79], v[40:43]
    ds_read_b64_tr_b16 v[148:149], v193 offset:1024
    ds_read_b64_tr_b16 v[150:151], v193 offset:1280
    v_mfma_f32_16x16x32_bf16 v[44:47], v[136:139], a[80:83], v[44:47]
    s_mov_b32 s42, 829440
    buffer_load_dwordx4 a[232:235], v188, s[8:11], s42 offen
    v_mfma_f32_16x16x32_bf16 v[48:51], v[136:139], a[84:87], v[48:51]
    buffer_load_dwordx4 a[236:239], v189, s[8:11], s42 offen
    v_mfma_f32_16x16x32_bf16 v[52:55], v[136:139], a[88:91], v[52:55]
    v_mfma_f32_16x16x32_bf16 v[56:59], v[136:139], a[92:95], v[56:59]
    v_mfma_f32_16x16x32_bf16 v[60:63], v[136:139], a[160:163], v[60:63]
    s_waitcnt lgkmcnt(0)
    v_lshlrev_b32 v156, 16, v144
    v_lshlrev_b32 v157, 16, v148
    v_mfma_f32_16x16x32_bf16 v[64:67], v[136:139], a[164:167], v[64:67]
    v_and_b32 v158, s41, v144
    v_and_b32 v159, s41, v148
    v_mfma_f32_16x16x32_bf16 v[68:71], v[136:139], a[168:171], v[68:71]
    v_add_f32 v156, v156, v157
    v_add_f32 v158, v158, v159
    v_mfma_f32_16x16x32_bf16 v[72:75], v[140:143], a[104:107], v[72:75]
    ds_read_b128 a[104:107], v196 offset:1152
    v_cvt_pk_bf16_f32 v152, v156, v158
    v_mfma_f32_16x16x32_bf16 v[76:79], v[140:143], a[108:111], v[76:79]
    v_lshlrev_b32 v160, 16, v145
    v_lshlrev_b32 v161, 16, v149
    v_mfma_f32_16x16x32_bf16 v[80:83], v[140:143], a[112:115], v[80:83]
    v_and_b32 v162, s41, v145
    v_and_b32 v163, s41, v149
    v_mfma_f32_16x16x32_bf16 v[84:87], v[140:143], a[116:119], v[84:87]
    v_add_f32 v160, v160, v161
    v_add_f32 v162, v162, v163
    v_mfma_f32_16x16x32_bf16 v[88:91], v[140:143], a[120:123], v[88:91]
    v_cvt_pk_bf16_f32 v153, v160, v162
    v_lshlrev_b32 v156, 16, v146
    v_mfma_f32_16x16x32_bf16 v[92:95], v[140:143], a[124:127], v[92:95]
    v_lshlrev_b32 v157, 16, v150
    v_and_b32 v158, s41, v146
    v_mfma_f32_16x16x32_bf16 v[96:99], v[140:143], a[128:131], v[96:99]
    v_and_b32 v159, s41, v150
    v_add_f32 v156, v156, v157
    v_mfma_f32_16x16x32_bf16 v[100:103], v[140:143], a[132:135], v[100:103]
    v_add_f32 v158, v158, v159
    v_cvt_pk_bf16_f32 v154, v156, v158
    v_mfma_f32_16x16x32_bf16 v[104:107], v[140:143], a[136:139], v[104:107]
    v_lshlrev_b32 v160, 16, v147
    v_lshlrev_b32 v161, 16, v151
    v_mfma_f32_16x16x32_bf16 v[0:3], v[144:147], a[12:15], v[0:3]
    v_and_b32 v162, s41, v147
    v_and_b32 v163, s41, v151
    v_mfma_f32_16x16x32_bf16 v[4:7], v[144:147], a[16:19], v[4:7]
    v_add_f32 v160, v160, v161
    v_add_f32 v162, v162, v163
    v_mfma_f32_16x16x32_bf16 v[8:11], v[144:147], a[20:23], v[8:11]
    v_cvt_pk_bf16_f32 v155, v160, v162
    v_mfma_f32_16x16x32_bf16 v[12:15], v[144:147], a[24:27], v[12:15]
    v_mfma_f32_16x16x32_bf16 v[16:19], v[144:147], a[28:31], v[16:19]
    v_mfma_f32_16x16x32_bf16 v[20:23], v[144:147], a[32:35], v[20:23]
    v_mfma_f32_16x16x32_bf16 v[24:27], v[144:147], a[36:39], v[24:27]
    v_mfma_f32_16x16x32_bf16 v[28:31], v[144:147], a[40:43], v[28:31]
    s_waitcnt vmcnt(2)
    ds_write_b128 v192, a[224:227] offset:0
    v_mfma_f32_16x16x32_bf16 v[32:35], v[144:147], a[44:47], v[32:35]
    ds_write_b128 v192, a[228:231] offset:1024
    v_mfma_f32_16x16x32_bf16 v[36:39], v[148:151], a[76:79], v[36:39]
    ds_read_b64_tr_b16 v[108:109], v193 offset:0
    ds_read_b64_tr_b16 v[110:111], v193 offset:256
    v_mfma_f32_16x16x32_bf16 v[40:43], v[148:151], a[80:83], v[40:43]
    ds_read_b64_tr_b16 v[112:113], v193 offset:1024
    ds_read_b64_tr_b16 v[114:115], v193 offset:1280
    v_mfma_f32_16x16x32_bf16 v[44:47], v[148:151], a[84:87], v[44:47]
    s_mov_b32 s42, 995328
    buffer_load_dwordx4 a[240:243], v188, s[8:11], s42 offen
    v_mfma_f32_16x16x32_bf16 v[48:51], v[148:151], a[88:91], v[48:51]
    buffer_load_dwordx4 a[244:247], v189, s[8:11], s42 offen
    v_mfma_f32_16x16x32_bf16 v[52:55], v[148:151], a[92:95], v[52:55]
    v_mfma_f32_16x16x32_bf16 v[56:59], v[148:151], a[160:163], v[56:59]
    v_mfma_f32_16x16x32_bf16 v[60:63], v[148:151], a[164:167], v[60:63]
    s_waitcnt lgkmcnt(0)
    v_lshlrev_b32 v156, 16, v108
    v_lshlrev_b32 v157, 16, v112
    v_mfma_f32_16x16x32_bf16 v[64:67], v[148:151], a[168:171], v[64:67]
    v_and_b32 v158, s41, v108
    v_and_b32 v159, s41, v112
    v_mfma_f32_16x16x32_bf16 v[68:71], v[148:151], a[172:175], v[68:71]
    v_add_f32 v156, v156, v157
    v_add_f32 v158, v158, v159
    v_mfma_f32_16x16x32_bf16 v[72:75], v[152:155], a[108:111], v[72:75]
    ds_read_b128 a[108:111], v196 offset:1728
    v_cvt_pk_bf16_f32 v116, v156, v158
    v_mfma_f32_16x16x32_bf16 v[76:79], v[152:155], a[112:115], v[76:79]
    v_lshlrev_b32 v160, 16, v109
    v_lshlrev_b32 v161, 16, v113
    v_mfma_f32_16x16x32_bf16 v[80:83], v[152:155], a[116:119], v[80:83]
    v_and_b32 v162, s41, v109
    v_and_b32 v163, s41, v113
    v_mfma_f32_16x16x32_bf16 v[84:87], v[152:155], a[120:123], v[84:87]
    v_add_f32 v160, v160, v161
    v_add_f32 v162, v162, v163
    v_mfma_f32_16x16x32_bf16 v[88:91], v[152:155], a[124:127], v[88:91]
    v_cvt_pk_bf16_f32 v117, v160, v162
    v_lshlrev_b32 v156, 16, v110
    v_mfma_f32_16x16x32_bf16 v[92:95], v[152:155], a[128:131], v[92:95]
    v_lshlrev_b32 v157, 16, v114
    v_and_b32 v158, s41, v110
    v_mfma_f32_16x16x32_bf16 v[96:99], v[152:155], a[132:135], v[96:99]
    v_and_b32 v159, s41, v114
    v_add_f32 v156, v156, v157
    v_mfma_f32_16x16x32_bf16 v[100:103], v[152:155], a[136:139], v[100:103]
    v_add_f32 v158, v158, v159
    v_cvt_pk_bf16_f32 v118, v156, v158
    v_mfma_f32_16x16x32_bf16 v[104:107], v[152:155], a[140:143], v[104:107]
    v_lshlrev_b32 v160, 16, v111
    v_lshlrev_b32 v161, 16, v115
    v_mfma_f32_16x16x32_bf16 v[0:3], v[108:111], a[16:19], v[0:3]
    v_and_b32 v162, s41, v111
    v_and_b32 v163, s41, v115
    v_mfma_f32_16x16x32_bf16 v[4:7], v[108:111], a[20:23], v[4:7]
    v_add_f32 v160, v160, v161
    v_add_f32 v162, v162, v163
    v_mfma_f32_16x16x32_bf16 v[8:11], v[108:111], a[24:27], v[8:11]
    v_cvt_pk_bf16_f32 v119, v160, v162
    v_mfma_f32_16x16x32_bf16 v[12:15], v[108:111], a[28:31], v[12:15]
    v_mfma_f32_16x16x32_bf16 v[16:19], v[108:111], a[32:35], v[16:19]
    v_mfma_f32_16x16x32_bf16 v[20:23], v[108:111], a[36:39], v[20:23]
    v_mfma_f32_16x16x32_bf16 v[24:27], v[108:111], a[40:43], v[24:27]
    v_mfma_f32_16x16x32_bf16 v[28:31], v[108:111], a[44:47], v[28:31]
    s_waitcnt vmcnt(2)
    ds_write_b128 v192, a[232:235] offset:0
    v_mfma_f32_16x16x32_bf16 v[32:35], v[108:111], a[48:51], v[32:35]
    ds_write_b128 v192, a[236:239] offset:1024
    v_mfma_f32_16x16x32_bf16 v[36:39], v[112:115], a[80:83], v[36:39]
    ds_read_b64_tr_b16 v[120:121], v193 offset:0
    ds_read_b64_tr_b16 v[122:123], v193 offset:256
    v_mfma_f32_16x16x32_bf16 v[40:43], v[112:115], a[84:87], v[40:43]
    ds_read_b64_tr_b16 v[124:125], v193 offset:1024
    ds_read_b64_tr_b16 v[126:127], v193 offset:1280
    v_mfma_f32_16x16x32_bf16 v[44:47], v[112:115], a[88:91], v[44:47]
    s_mov_b32 s42, 1161216
    buffer_load_dwordx4 a[248:251], v188, s[8:11], s42 offen
    v_mfma_f32_16x16x32_bf16 v[48:51], v[112:115], a[92:95], v[48:51]
    buffer_load_dwordx4 a[252:255], v189, s[8:11], s42 offen
    v_mfma_f32_16x16x32_bf16 v[52:55], v[112:115], a[160:163], v[52:55]
    v_mfma_f32_16x16x32_bf16 v[56:59], v[112:115], a[164:167], v[56:59]
    v_mfma_f32_16x16x32_bf16 v[60:63], v[112:115], a[168:171], v[60:63]
    s_waitcnt lgkmcnt(0)
    v_lshlrev_b32 v156, 16, v120
    v_lshlrev_b32 v157, 16, v124
    v_mfma_f32_16x16x32_bf16 v[64:67], v[112:115], a[172:175], v[64:67]
    v_and_b32 v158, s41, v120
    v_and_b32 v159, s41, v124
    v_mfma_f32_16x16x32_bf16 v[68:71], v[112:115], a[176:179], v[68:71]
    v_add_f32 v156, v156, v157
    v_add_f32 v158, v158, v159
    v_mfma_f32_16x16x32_bf16 v[72:75], v[116:119], a[112:115], v[72:75]
    ds_read_b128 a[112:115], v196 offset:2304
    v_cvt_pk_bf16_f32 v128, v156, v158
    v_mfma_f32_16x16x32_bf16 v[76:79], v[116:119], a[116:119], v[76:79]
    v_lshlrev_b32 v160, 16, v121
    v_lshlrev_b32 v161, 16, v125
    v_mfma_f32_16x16x32_bf16 v[80:83], v[116:119], a[120:123], v[80:83]
    v_and_b32 v162, s41, v121
    v_and_b32 v163, s41, v125
    v_mfma_f32_16x16x32_bf16 v[84:87], v[116:119], a[124:127], v[84:87]
    v_add_f32 v160, v160, v161
    v_add_f32 v162, v162, v163
    v_mfma_f32_16x16x32_bf16 v[88:91], v[116:119], a[128:131], v[88:91]
    v_cvt_pk_bf16_f32 v129, v160, v162
    v_lshlrev_b32 v156, 16, v122
    v_mfma_f32_16x16x32_bf16 v[92:95], v[116:119], a[132:135], v[92:95]
    v_lshlrev_b32 v157, 16, v126
    v_and_b32 v158, s41, v122
    v_mfma_f32_16x16x32_bf16 v[96:99], v[116:119], a[136:139], v[96:99]
    v_and_b32 v159, s41, v126
    v_add_f32 v156, v156, v157
    v_mfma_f32_16x16x32_bf16 v[100:103], v[116:119], a[140:143], v[100:103]
    v_add_f32 v158, v158, v159
    v_cvt_pk_bf16_f32 v130, v156, v158
    v_mfma_f32_16x16x32_bf16 v[104:107], v[116:119], a[144:147], v[104:107]
    v_lshlrev_b32 v160, 16, v123
    v_lshlrev_b32 v161, 16, v127
    v_mfma_f32_16x16x32_bf16 v[0:3], v[120:123], a[20:23], v[0:3]
    v_and_b32 v162, s41, v123
    v_and_b32 v163, s41, v127
    v_mfma_f32_16x16x32_bf16 v[4:7], v[120:123], a[24:27], v[4:7]
    v_add_f32 v160, v160, v161
    v_add_f32 v162, v162, v163
    v_mfma_f32_16x16x32_bf16 v[8:11], v[120:123], a[28:31], v[8:11]
    v_cvt_pk_bf16_f32 v131, v160, v162
    v_mfma_f32_16x16x32_bf16 v[12:15], v[120:123], a[32:35], v[12:15]
    v_mfma_f32_16x16x32_bf16 v[16:19], v[120:123], a[36:39], v[16:19]
    v_mfma_f32_16x16x32_bf16 v[20:23], v[120:123], a[40:43], v[20:23]
    v_mfma_f32_16x16x32_bf16 v[24:27], v[120:123], a[44:47], v[24:27]
    v_mfma_f32_16x16x32_bf16 v[28:31], v[120:123], a[48:51], v[28:31]
    s_waitcnt vmcnt(2)
    ds_write_b128 v192, a[240:243] offset:0
    v_mfma_f32_16x16x32_bf16 v[32:35], v[120:123], a[52:55], v[32:35]
    ds_write_b128 v192, a[244:247] offset:1024
    v_mfma_f32_16x16x32_bf16 v[36:39], v[124:127], a[84:87], v[36:39]
    ds_read_b64_tr_b16 v[132:133], v193 offset:0
    ds_read_b64_tr_b16 v[134:135], v193 offset:256
    v_mfma_f32_16x16x32_bf16 v[40:43], v[124:127], a[88:91], v[40:43]
    s_mov_b32 exec_lo, 0xf
    s_mov_b32 exec_hi, 0xf
    buffer_load_dwordx2 v[202:203], v208, s[16:19], 0 offen sc1
    s_mov_b64 exec, -1
    v_mfma_f32_16x16x32_bf16 v[44:47], v[124:127], a[92:95], v[44:47]
    ds_read_b64_tr_b16 v[136:137], v193 offset:1024
    ds_read_b64_tr_b16 v[138:139], v193 offset:1280
    v_mfma_f32_16x16x32_bf16 v[48:51], v[124:127], a[160:163], v[48:51]
    v_mfma_f32_16x16x32_bf16 v[52:55], v[124:127], a[164:167], v[52:55]
    v_mfma_f32_16x16x32_bf16 v[56:59], v[124:127], a[168:171], v[56:59]
    v_mfma_f32_16x16x32_bf16 v[60:63], v[124:127], a[172:175], v[60:63]
    s_waitcnt lgkmcnt(0)
    v_lshlrev_b32 v156, 16, v132
    v_lshlrev_b32 v157, 16, v136
    v_mfma_f32_16x16x32_bf16 v[64:67], v[124:127], a[176:179], v[64:67]
    v_and_b32 v158, s41, v132
    v_and_b32 v159, s41, v136
    v_mfma_f32_16x16x32_bf16 v[68:71], v[124:127], a[180:183], v[68:71]
    v_add_f32 v156, v156, v157
    v_add_f32 v158, v158, v159
    v_mfma_f32_16x16x32_bf16 v[72:75], v[128:131], a[116:119], v[72:75]
    ds_read_b128 a[116:119], v196 offset:2880
    v_cvt_pk_bf16_f32 v140, v156, v158
    v_mfma_f32_16x16x32_bf16 v[76:79], v[128:131], a[120:123], v[76:79]
    v_lshlrev_b32 v160, 16, v133
    v_lshlrev_b32 v161, 16, v137
    v_mfma_f32_16x16x32_bf16 v[80:83], v[128:131], a[124:127], v[80:83]
    v_and_b32 v162, s41, v133
    v_and_b32 v163, s41, v137
    v_mfma_f32_16x16x32_bf16 v[84:87], v[128:131], a[128:131], v[84:87]
    v_add_f32 v160, v160, v161
    v_add_f32 v162, v162, v163
    v_mfma_f32_16x16x32_bf16 v[88:91], v[128:131], a[132:135], v[88:91]
    v_cvt_pk_bf16_f32 v141, v160, v162
    v_lshlrev_b32 v156, 16, v134
    v_mfma_f32_16x16x32_bf16 v[92:95], v[128:131], a[136:139], v[92:95]
    v_lshlrev_b32 v157, 16, v138
    v_and_b32 v158, s41, v134
    v_mfma_f32_16x16x32_bf16 v[96:99], v[128:131], a[140:143], v[96:99]
    v_and_b32 v159, s41, v138
    v_add_f32 v156, v156, v157
    v_mfma_f32_16x16x32_bf16 v[100:103], v[128:131], a[144:147], v[100:103]
    v_add_f32 v158, v158, v159
    v_cvt_pk_bf16_f32 v142, v156, v158
    v_mfma_f32_16x16x32_bf16 v[104:107], v[128:131], a[148:151], v[104:107]
    v_lshlrev_b32 v160, 16, v135
    v_lshlrev_b32 v161, 16, v139
    v_mfma_f32_16x16x32_bf16 v[0:3], v[132:135], a[24:27], v[0:3]
    v_and_b32 v162, s41, v135
    v_and_b32 v163, s41, v139
    v_mfma_f32_16x16x32_bf16 v[4:7], v[132:135], a[28:31], v[4:7]
    v_add_f32 v160, v160, v161
    v_add_f32 v162, v162, v163
    v_mfma_f32_16x16x32_bf16 v[8:11], v[132:135], a[32:35], v[8:11]
    v_cvt_pk_bf16_f32 v143, v160, v162
    v_mfma_f32_16x16x32_bf16 v[12:15], v[132:135], a[36:39], v[12:15]
    v_mfma_f32_16x16x32_bf16 v[16:19], v[132:135], a[40:43], v[16:19]
    v_mfma_f32_16x16x32_bf16 v[20:23], v[132:135], a[44:47], v[20:23]
    v_mfma_f32_16x16x32_bf16 v[24:27], v[132:135], a[48:51], v[24:27]
    v_mfma_f32_16x16x32_bf16 v[28:31], v[132:135], a[52:55], v[28:31]
    s_waitcnt vmcnt(1)
    ds_write_b128 v192, a[248:251] offset:0
    v_mfma_f32_16x16x32_bf16 v[32:35], v[132:135], a[56:59], v[32:35]
    ds_write_b128 v192, a[252:255] offset:1024
    v_mfma_f32_16x16x32_bf16 v[36:39], v[136:139], a[88:91], v[36:39]
    ds_read_b64_tr_b16 v[144:145], v193 offset:0
    ds_read_b64_tr_b16 v[146:147], v193 offset:256
    v_mfma_f32_16x16x32_bf16 v[40:43], v[136:139], a[92:95], v[40:43]
    ds_read_b64_tr_b16 v[148:149], v193 offset:1024
    ds_read_b64_tr_b16 v[150:151], v193 offset:1280
    v_mfma_f32_16x16x32_bf16 v[44:47], v[136:139], a[160:163], v[44:47]
    v_mfma_f32_16x16x32_bf16 v[48:51], v[136:139], a[164:167], v[48:51]
    v_mfma_f32_16x16x32_bf16 v[52:55], v[136:139], a[168:171], v[52:55]
    v_mfma_f32_16x16x32_bf16 v[56:59], v[136:139], a[172:175], v[56:59]
    v_mfma_f32_16x16x32_bf16 v[60:63], v[136:139], a[176:179], v[60:63]
    s_waitcnt lgkmcnt(0)
    v_lshlrev_b32 v156, 16, v144
    v_lshlrev_b32 v157, 16, v148
    v_mfma_f32_16x16x32_bf16 v[64:67], v[136:139], a[180:183], v[64:67]
    s_waitcnt vmcnt(0)
    s_mov_b32 exec_lo, 0xf
    s_mov_b32 exec_hi, 0xf
    v_cmp_le_u64 vcc, s[98:99], v[202:203]
    v_cmp_gt_u64 s[36:37], s[100:101], v[202:203]
    s_nop 3
    s_and_b64 vcc, vcc, s[36:37]
    s_cmp_eq_u64 vcc, exec
    s_cbranch_scc0 L_f1spin
L_f1back:
    s_mov_b64 exec, -1
    v_mfma_f32_16x16x32_bf16 v[68:71], v[136:139], a[184:187], v[68:71]
    s_mov_b32 exec_lo, 0xff0
    s_mov_b32 exec_hi, 0xff0
    buffer_load_dwordx2 v[202:203], v208, s[16:19], 0 offen sc1
    s_mov_b64 exec, -1
    v_mfma_f32_16x16x32_bf16 v[72:75], v[140:143], a[120:123], v[72:75]
    s_add_u32 s55, s56, 8192
    buffer_load_dwordx4 v[164:167], v207, s[16:19], s55 offen offset:0 sc1
    v_mfma_f32_16x16x32_bf16 v[76:79], v[140:143], a[124:127], v[76:79]
    ds_read_b128 a[120:123], v196 offset:3456
    v_and_b32 v158, s41, v144
    v_mfma_f32_16x16x32_bf16 v[80:83], v[140:143], a[128:131], v[80:83]
    v_and_b32 v159, s41, v148
    v_add_f32 v156, v156, v157
    v_mfma_f32_16x16x32_bf16 v[84:87], v[140:143], a[132:135], v[84:87]
    buffer_load_dwordx4 v[168:171], v207, s[16:19], s55 offen offset:1024 sc1
    v_add_f32 v158, v158, v159
    v_mfma_f32_16x16x32_bf16 v[88:91], v[140:143], a[136:139], v[88:91]
    v_cvt_pk_bf16_f32 v152, v156, v158
    v_lshlrev_b32 v160, 16, v145
    v_mfma_f32_16x16x32_bf16 v[92:95], v[140:143], a[140:143], v[92:95]
    v_lshlrev_b32 v161, 16, v149
    v_and_b32 v162, s41, v145
    v_mfma_f32_16x16x32_bf16 v[96:99], v[140:143], a[144:147], v[96:99]
    buffer_load_dwordx4 v[172:175], v207, s[16:19], s55 offen offset:2048 sc1
    v_and_b32 v163, s41, v149
    v_mfma_f32_16x16x32_bf16 v[100:103], v[140:143], a[148:151], v[100:103]
    v_add_f32 v160, v160, v161
    v_add_f32 v162, v162, v163
    v_mfma_f32_16x16x32_bf16 v[104:107], v[140:143], a[152:155], v[104:107]
    v_cvt_pk_bf16_f32 v153, v160, v162
    v_lshlrev_b32 v156, 16, v146
    v_lshlrev_b32 v157, 16, v150
    v_and_b32 v158, s41, v146
    v_and_b32 v159, s41, v150
    v_add_f32 v156, v156, v157
    v_add_f32 v158, v158, v159
    v_cvt_pk_bf16_f32 v154, v156, v158
    v_lshlrev_b32 v160, 16, v147
    v_lshlrev_b32 v161, 16, v151
    v_and_b32 v162, s41, v147
    v_and_b32 v163, s41, v151
    v_add_f32 v160, v160, v161
    v_add_f32 v162, v162, v163
    v_cvt_pk_bf16_f32 v155, v160, v162
    s_nop 1
    v_mfma_f32_16x16x32_bf16 v[72:75], v[152:155], a[124:127], v[72:75]
    buffer_load_dwordx4 v[176:179], v207, s[16:19], s55 offen offset:3072 sc1
    ds_read_b128 a[124:127], v196 offset:4032
    v_mfma_f32_16x16x32_bf16 v[76:79], v[152:155], a[128:131], v[76:79]
    v_mfma_f32_16x16x32_bf16 v[80:83], v[152:155], a[132:135], v[80:83]
    ds_read_b128 a[128:131], v196 offset:4608
    v_mfma_f32_16x16x32_bf16 v[84:87], v[152:155], a[136:139], v[84:87]
    s_add_u32 s55, s56, 0
    buffer_load_dwordx4 a[224:227], v207, s[16:19], s55 offen offset:0 sc1
    v_mfma_f32_16x16x32_bf16 v[88:91], v[152:155], a[140:143], v[88:91]
    ds_read_b128 a[132:135], v196 offset:5184
    v_mfma_f32_16x16x32_bf16 v[92:95], v[152:155], a[144:147], v[92:95]
    v_mfma_f32_16x16x32_bf16 v[96:99], v[152:155], a[148:151], v[96:99]
    buffer_load_dwordx4 a[228:231], v207, s[16:19], s55 offen offset:1024 sc1
    ds_read_b128 a[136:139], v196 offset:5760
    v_mfma_f32_16x16x32_bf16 v[100:103], v[152:155], a[152:155], v[100:103]
    v_mfma_f32_16x16x32_bf16 v[104:107], v[152:155], a[156:159], v[104:107]
    ds_read_b128 a[140:143], v196 offset:6336
    v_mfma_f32_16x16x32_bf16 v[36:39], v[148:151], a[92:95], v[36:39]
    buffer_load_dwordx4 a[232:235], v207, s[16:19], s55 offen offset:2048 sc1
    v_mfma_f32_16x16x32_bf16 v[40:43], v[148:151], a[160:163], v[40:43]
    ds_read_b128 a[0:3], v242 offset:0
    v_mfma_f32_16x16x32_bf16 v[44:47], v[148:151], a[164:167], v[44:47]
    v_mfma_f32_16x16x32_bf16 v[48:51], v[148:151], a[168:171], v[48:51]
    buffer_load_dwordx4 a[236:239], v207, s[16:19], s55 offen offset:3072 sc1
    ds_read_b128 a[4:7], v242 offset:576
    v_mfma_f32_16x16x32_bf16 v[52:55], v[148:151], a[172:175], v[52:55]
    v_mfma_f32_16x16x32_bf16 v[56:59], v[148:151], a[176:179], v[56:59]
    ds_read_b128 a[8:11], v242 offset:1152
    v_mfma_f32_16x16x32_bf16 v[60:63], v[148:151], a[180:183], v[60:63]
    s_add_u32 s55, s56, 4096
    buffer_load_dwordx4 a[192:195], v207, s[16:19], s55 offen offset:0 sc1
    v_mfma_f32_16x16x32_bf16 v[64:67], v[148:151], a[184:187], v[64:67]
    s_waitcnt vmcnt(9)
    s_mov_b32 exec_lo, 0xff0
    s_mov_b32 exec_hi, 0xff0
    v_cmp_le_u64 vcc, s[98:99], v[202:203]
    v_cmp_gt_u64 s[36:37], s[100:101], v[202:203]
    s_nop 3
    s_and_b64 vcc, vcc, s[36:37]
    s_cmp_eq_u64 vcc, exec
    s_cbranch_scc0 L_f2spin
L_f2back:
    s_mov_b64 exec, -1
    v_mfma_f32_16x16x32_bf16 v[68:71], v[148:151], a[188:191], v[68:71]
    s_mov_b32 exec_lo, 0xffff000
    s_mov_b32 exec_hi, 0xffff000
    buffer_load_dwordx2 v[202:203], v208, s[16:19], 0 offen sc1
    s_mov_b64 exec, -1
    v_mfma_f32_16x16x32_bf16 v[0:3], v[144:147], a[28:31], v[0:3]
    ds_read_b128 a[12:15], v242 offset:1728
    ds_read_b128 a[16:19], v242 offset:2304
    v_mfma_f32_16x16x32_bf16 v[4:7], v[144:147], a[32:35], v[4:7]
    v_mfma_f32_16x16x32_bf16 v[8:11], v[144:147], a[36:39], v[8:11]
    ds_read_b128 a[20:23], v242 offset:2880
    v_mfma_f32_16x16x32_bf16 v[12:15], v[144:147], a[40:43], v[12:15]
    v_mfma_f32_16x16x32_bf16 v[16:19], v[144:147], a[44:47], v[16:19]
    s_add_u32 s55, s56, 28672
    buffer_load_dwordx4 v[210:213], v207, s[16:19], s55 offen offset:0 sc1
    v_mfma_f32_16x16x32_bf16 v[20:23], v[144:147], a[48:51], v[20:23]
    ds_read_b128 a[24:27], v242 offset:3456
    v_mfma_f32_16x16x32_bf16 v[24:27], v[144:147], a[52:55], v[24:27]
    ds_read_b128 a[28:31], v242 offset:4032
    v_mfma_f32_16x16x32_bf16 v[28:31], v[144:147], a[56:59], v[28:31]
    v_mfma_f32_16x16x32_bf16 v[32:35], v[144:147], a[60:63], v[32:35]
    ds_read_b128 a[32:35], v242 offset:4608
    s_waitcnt vmcnt(10) lgkmcnt(9)
    v_mfma_f32_16x16x32_bf16 v[72:75], v[164:167], a[96:99], v[72:75]
    s_waitcnt vmcnt(9)
    v_mfma_f32_16x16x32_bf16 v[72:75], v[168:171], a[100:103], v[72:75]
    ds_read_b128 a[36:39], v242 offset:5184
    s_waitcnt vmcnt(8) lgkmcnt(9)
    v_mfma_f32_16x16x32_bf16 v[72:75], v[172:175], a[104:107], v[72:75]
    buffer_load_dwordx4 v[214:217], v207, s[16:19], s55 offen offset:1024 sc1
    s_waitcnt vmcnt(8)
    v_mfma_f32_16x16x32_bf16 v[72:75], v[176:179], a[108:111], v[72:75]
    ds_read_b128 a[40:43], v242 offset:5760
    v_mfma_f32_16x16x32_bf16 v[76:79], v[164:167], a[100:103], v[76:79]
    s_add_u32 s12, s28, s43
    s_addc_u32 s13, s29, 0
    v_mfma_f32_16x16x32_bf16 v[76:79], v[168:171], a[104:107], v[76:79]
    ds_read_b128 a[44:47], v242 offset:6336
    s_mov_b32 s14, 1152000
    v_mfma_f32_16x16x32_bf16 v[76:79], v[172:175], a[108:111], v[76:79]
    s_mov_b32 s15, 0x20000
    v_bfe_u32 v246, v255, 1, 3
    v_mfma_f32_16x16x32_bf16 v[76:79], v[176:179], a[112:115], v[76:79]
    ds_read_b128 a[96:99], v198 offset:64
    v_and_b32 v247, 1, v255
    v_mfma_f32_16x16x32_bf16 v[80:83], v[164:167], a[104:107], v[80:83]
    v_lshrrev_b32 v248, 4, v255
    v_mul_u32_u24 v206, 10368, v246
    v_mfma_f32_16x16x32_bf16 v[80:83], v[168:171], a[108:111], v[80:83]
    buffer_load_dwordx4 v[218:221], v207, s[16:19], s55 offen offset:2048 sc1
    ds_read_b128 a[100:103], v198 offset:640
    v_mfma_f32_16x16x32_bf16 v[80:83], v[172:175], a[112:115], v[80:83]
    v_mul_u32_u24 v247, 288, v247
    v_lshlrev_b32 v248, 3, v248
    v_mfma_f32_16x16x32_bf16 v[80:83], v[176:179], a[116:119], v[80:83]
    ds_read_b128 a[104:107], v198 offset:1216
    v_add3_u32 v206, v206, v247, v248
    v_mfma_f32_16x16x32_bf16 v[84:87], v[164:167], a[108:111], v[84:87]
    s_mov_b32 s48, s63
    s_mul_i32 s49, s40, 576
    v_mfma_f32_16x16x32_bf16 v[84:87], v[168:171], a[112:115], v[84:87]
    ds_read_b128 a[108:111], v198 offset:1792
    s_add_u32 s48, s48, s49
    v_mfma_f32_16x16x32_bf16 v[84:87], v[172:175], a[116:119], v[84:87]
    s_lshl_b32 s49, s35, 5
    s_add_u32 s48, s48, s49
    v_mfma_f32_16x16x32_bf16 v[84:87], v[176:179], a[120:123], v[84:87]
    s_mul_i32 s49, s39, 1152
    s_add_u32 s48, s48, s49
    v_mfma_f32_16x16x32_bf16 v[88:91], v[164:167], a[112:115], v[88:91]
    buffer_load_dwordx4 v[222:225], v207, s[16:19], s55 offen offset:3072 sc1
    ds_read_b128 a[112:115], v198 offset:2368
    v_mfma_f32_16x16x32_bf16 v[88:91], v[168:171], a[116:119], v[88:91]
    v_add_u32 v206, s48, v206
    s_sub_u32 s47, 9216, s49
    v_mfma_f32_16x16x32_bf16 v[88:91], v[172:175], a[120:123], v[88:91]
    s_mul_i32 s48, s38, 9216
    s_add_u32 s48, s48, 50112
    v_mfma_f32_16x16x32_bf16 v[88:91], v[176:179], a[124:127], v[88:91]
    v_add_u32 v205, s48, v207
    s_xor_b32 s48, s38, 2
    v_mfma_f32_16x16x32_bf16 v[92:95], v[164:167], a[116:119], v[92:95]
    ds_read_b128 a[116:119], v198 offset:2944
    s_mul_i32 s48, s48, 9216
    v_mfma_f32_16x16x32_bf16 v[92:95], v[168:171], a[120:123], v[92:95]
    s_add_u32 s48, s48, 50112
    v_add_u32 v249, s48, v207
    v_mfma_f32_16x16x32_bf16 v[92:95], v[172:175], a[124:127], v[92:95]
    v_lshlrev_b32 v204, 3, v255
    s_lshl_b32 s48, s38, 9
    v_mfma_f32_16x16x32_bf16 v[92:95], v[176:179], a[128:131], v[92:95]
    s_add_u32 s55, s56, 32768
    buffer_load_dwordx4 v[226:229], v207, s[16:19], s55 offen offset:0 sc1
    v_mfma_f32_16x16x32_bf16 v[96:99], v[164:167], a[120:123], v[96:99]
    ds_read_b128 a[120:123], v198 offset:3520
    s_add_u32 s48, s48, 86976
    v_mfma_f32_16x16x32_bf16 v[96:99], v[168:171], a[124:127], v[96:99]
    v_add_u32 v200, s48, v204
    s_lshl_b32 s48, s40, 10
    v_mfma_f32_16x16x32_bf16 v[96:99], v[172:175], a[128:131], v[96:99]
    s_add_u32 s48, s48, 86976
    v_add_u32 v204, s48, v204
    v_mfma_f32_16x16x32_bf16 v[96:99], v[176:179], a[132:135], v[96:99]
    s_lshl_b32 s48, s39, 11
    v_add_u32 v201, s48, v204
    v_mfma_f32_16x16x32_bf16 v[100:103], v[164:167], a[124:127], v[100:103]
    ds_read_b128 a[124:127], v198 offset:4096
    v_mfma_f32_16x16x32_bf16 v[100:103], v[168:171], a[128:131], v[100:103]
    s_cmp_eq_u32 s39, 0
    s_mov_b32 s48, 0x4038aa3b
    s_mov_b32 s49, 0xbfb8aa3b
    s_cselect_b32 s48, s48, s49
    s_cselect_b32 s49, -2.0, 1.0
    s_cselect_b32 s50, 1.0, 0
    s_cselect_b32 s44, -1, 0
    s_cselect_b32 s45, 0, -1
    v_mfma_f32_16x16x32_bf16 v[100:103], v[172:175], a[132:135], v[100:103]
    buffer_load_dwordx4 v[230:233], v207, s[16:19], s55 offen offset:1024 sc1
    v_mov_b32 v199, s49
    v_mfma_f32_16x16x32_bf16 v[100:103], v[176:179], a[136:139], v[100:103]
    s_movk_i32 s60, 4608
    s_movk_i32 s46, 6912
    v_mfma_f32_16x16x32_bf16 v[104:107], v[164:167], a[128:131], v[104:107]
    ds_read_b128 a[128:131], v198 offset:4672
    v_mfma_f32_16x16x32_bf16 v[104:107], v[168:171], a[132:135], v[104:107]
    v_mfma_f32_16x16x32_bf16 v[104:107], v[172:175], a[136:139], v[104:107]
    ds_read_b128 a[132:135], v198 offset:5248
    v_mfma_f32_16x16x32_bf16 v[104:107], v[176:179], a[140:143], v[104:107]
    s_waitcnt vmcnt(11) lgkmcnt(5)
    v_mfma_f32_16x16x32_bf16 v[0:3], a[224:227], a[0:3], v[0:3]
    ds_read_b128 a[136:139], v198 offset:5824
    s_waitcnt vmcnt(10)
    v_mfma_f32_16x16x32_bf16 v[0:3], a[228:231], a[4:7], v[0:3]
    buffer_load_dwordx4 v[234:237], v207, s[16:19], s55 offen offset:2048 sc1
    s_waitcnt vmcnt(10)
    v_mfma_f32_16x16x32_bf16 v[0:3], a[232:235], a[8:11], v[0:3]
    ds_read_b128 a[140:143], v198 offset:6400
    s_waitcnt vmcnt(9) lgkmcnt(6)
    v_mfma_f32_16x16x32_bf16 v[0:3], a[236:239], a[12:15], v[0:3]
    v_mfma_f32_16x16x32_bf16 v[4:7], a[224:227], a[4:7], v[4:7]
    ds_read_b128 a[144:147], v198 offset:6976
    v_mfma_f32_16x16x32_bf16 v[4:7], a[228:231], a[8:11], v[4:7]
    v_mfma_f32_16x16x32_bf16 v[4:7], a[232:235], a[12:15], v[4:7]
    ds_read_b128 a[148:151], v198 offset:7552
    v_mfma_f32_16x16x32_bf16 v[4:7], a[236:239], a[16:19], v[4:7]
    v_mfma_f32_16x16x32_bf16 v[8:11], a[224:227], a[8:11], v[8:11]
    buffer_load_dwordx4 v[238:241], v207, s[16:19], s55 offen offset:3072 sc1
    ds_read_b128 a[152:155], v198 offset:8128
    v_mfma_f32_16x16x32_bf16 v[8:11], a[228:231], a[12:15], v[8:11]
    v_mfma_f32_16x16x32_bf16 v[8:11], a[232:235], a[16:19], v[8:11]
    ds_read_b128 a[156:159], v198 offset:8704
    v_mfma_f32_16x16x32_bf16 v[8:11], a[236:239], a[20:23], v[8:11]
    v_mfma_f32_16x16x32_bf16 v[12:15], a[224:227], a[12:15], v[12:15]
    ds_read_b128 a[48:51], v242 offset:6912
    v_mfma_f32_16x16x32_bf16 v[12:15], a[228:231], a[16:19], v[12:15]
    v_mfma_f32_16x16x32_bf16 v[12:15], a[232:235], a[20:23], v[12:15]
    ds_read_b128 a[52:55], v242 offset:7488
    v_mfma_f32_16x16x32_bf16 v[12:15], a[236:239], a[24:27], v[12:15]
    s_add_u32 s55, s56, 4096
    buffer_load_dwordx4 a[196:199], v207, s[16:19], s55 offen offset:1024 sc1
    v_mfma_f32_16x16x32_bf16 v[16:19], a[224:227], a[16:19], v[16:19]
    ds_read_b128 a[56:59], v242 offset:8064
    v_mfma_f32_16x16x32_bf16 v[16:19], a[228:231], a[20:23], v[16:19]
    v_mfma_f32_16x16x32_bf16 v[16:19], a[232:235], a[24:27], v[16:19]
    ds_read_b128 a[60:63], v242 offset:8640
    v_mfma_f32_16x16x32_bf16 v[16:19], a[236:239], a[28:31], v[16:19]
    v_mfma_f32_16x16x32_bf16 v[20:23], a[224:227], a[20:23], v[20:23]
    ds_read_b128 a[64:67], v242 offset:9216
    v_mfma_f32_16x16x32_bf16 v[20:23], a[228:231], a[24:27], v[20:23]
    v_mfma_f32_16x16x32_bf16 v[20:23], a[232:235], a[28:31], v[20:23]
    buffer_load_dwordx4 a[200:203], v207, s[16:19], s55 offen offset:2048 sc1
    ds_read_b128 a[68:71], v242 offset:9792
    v_mfma_f32_16x16x32_bf16 v[20:23], a[236:239], a[32:35], v[20:23]
    v_mfma_f32_16x16x32_bf16 v[24:27], a[224:227], a[24:27], v[24:27]
    s_waitcnt vmcnt(10)
    s_mov_b32 exec_lo, 0xffff000
    s_mov_b32 exec_hi, 0xffff000
    v_cmp_le_u64 vcc, s[98:99], v[202:203]
    v_cmp_gt_u64 s[36:37], s[100:101], v[202:203]
    s_nop 3
    s_and_b64 vcc, vcc, s[36:37]
    s_cmp_eq_u64 vcc, exec
    s_cbranch_scc0 L_f3spin
L_f3back:
    s_mov_b64 exec, -1
    v_mfma_f32_16x16x32_bf16 v[24:27], a[228:231], a[28:31], v[24:27]
    ds_read_b128 a[72:75], v242 offset:10368
    v_mfma_f32_16x16x32_bf16 v[24:27], a[232:235], a[32:35], v[24:27]
    ds_read_b128 a[76:79], v242 offset:10944
    v_mfma_f32_16x16x32_bf16 v[24:27], a[236:239], a[36:39], v[24:27]
    v_mfma_f32_16x16x32_bf16 v[28:31], a[224:227], a[28:31], v[28:31]
    v_mfma_f32_16x16x32_bf16 v[28:31], a[228:231], a[32:35], v[28:31]
    buffer_load_dwordx4 a[204:207], v207, s[16:19], s55 offen offset:3072 sc1
    v_mfma_f32_16x16x32_bf16 v[28:31], a[232:235], a[36:39], v[28:31]
    v_mfma_f32_16x16x32_bf16 v[28:31], a[236:239], a[40:43], v[28:31]
    v_mfma_f32_16x16x32_bf16 v[32:35], a[224:227], a[32:35], v[32:35]
    v_mfma_f32_16x16x32_bf16 v[32:35], a[228:231], a[36:39], v[32:35]
    v_mfma_f32_16x16x32_bf16 v[32:35], a[232:235], a[40:43], v[32:35]
    v_mfma_f32_16x16x32_bf16 v[32:35], a[236:239], a[44:47], v[32:35]
    s_waitcnt vmcnt(10) lgkmcnt(5)
    v_mfma_f32_16x16x32_bf16 v[72:75], v[210:213], a[96:99], v[72:75]
    s_add_u32 s55, s56, 53248
    buffer_load_dwordx4 v[108:111], v207, s[16:19], s55 offen offset:0 sc1
    s_waitcnt vmcnt(10) lgkmcnt(4)
    v_mfma_f32_16x16x32_bf16 v[72:75], v[214:217], a[100:103], v[72:75]
    ds_read_b128 a[96:99], v198 offset:128
    s_waitcnt vmcnt(9)
    v_mfma_f32_16x16x32_bf16 v[72:75], v[218:221], a[104:107], v[72:75]
    s_waitcnt vmcnt(8) lgkmcnt(4)
    v_mfma_f32_16x16x32_bf16 v[72:75], v[222:225], a[108:111], v[72:75]
    s_waitcnt vmcnt(7)
    v_mfma_f32_16x16x32_bf16 v[72:75], v[226:229], a[112:115], v[72:75]
    s_waitcnt vmcnt(6) lgkmcnt(3)
    v_mfma_f32_16x16x32_bf16 v[72:75], v[230:233], a[116:119], v[72:75]
    s_waitcnt vmcnt(5)
    v_mfma_f32_16x16x32_bf16 v[72:75], v[234:237], a[120:123], v[72:75]
    s_waitcnt vmcnt(4)
    v_mfma_f32_16x16x32_bf16 v[72:75], v[238:241], a[124:127], v[72:75]
    buffer_load_dwordx4 v[112:115], v207, s[16:19], s55 offen offset:1024 sc1
    v_mfma_f32_16x16x32_bf16 v[76:79], v[210:213], a[100:103], v[76:79]
    ds_read_b128 a[100:103], v198 offset:704
    v_mfma_f32_16x16x32_bf16 v[76:79], v[214:217], a[104:107], v[76:79]
    v_mfma_f32_16x16x32_bf16 v[76:79], v[218:221], a[108:111], v[76:79]
    v_mfma_f32_16x16x32_bf16 v[76:79], v[222:225], a[112:115], v[76:79]
    v_mfma_f32_16x16x32_bf16 v[76:79], v[226:229], a[116:119], v[76:79]
    v_mfma_f32_16x16x32_bf16 v[76:79], v[230:233], a[120:123], v[76:79]
    v_mfma_f32_16x16x32_bf16 v[76:79], v[234:237], a[124:127], v[76:79]
    buffer_load_dwordx4 v[116:119], v207, s[16:19], s55 offen offset:2048 sc1
    v_mfma_f32_16x16x32_bf16 v[76:79], v[238:241], a[128:131], v[76:79]
    v_mfma_f32_16x16x32_bf16 v[80:83], v[210:213], a[104:107], v[80:83]
    ds_read_b128 a[104:107], v198 offset:1280
    v_mfma_f32_16x16x32_bf16 v[80:83], v[214:217], a[108:111], v[80:83]
    v_mfma_f32_16x16x32_bf16 v[80:83], v[218:221], a[112:115], v[80:83]
    v_mfma_f32_16x16x32_bf16 v[80:83], v[222:225], a[116:119], v[80:83]
    v_mfma_f32_16x16x32_bf16 v[80:83], v[226:229], a[120:123], v[80:83]
    v_mfma_f32_16x16x32_bf16 v[80:83], v[230:233], a[124:127], v[80:83]
    buffer_load_dwordx4 v[120:123], v207, s[16:19], s55 offen offset:3072 sc1
    v_mfma_f32_16x16x32_bf16 v[80:83], v[234:237], a[128:131], v[80:83]
    v_mfma_f32_16x16x32_bf16 v[80:83], v[238:241], a[132:135], v[80:83]
    v_mfma_f32_16x16x32_bf16 v[84:87], v[210:213], a[108:111], v[84:87]
    ds_read_b128 a[108:111], v198 offset:1856
    v_mfma_f32_16x16x32_bf16 v[84:87], v[214:217], a[112:115], v[84:87]
    v_mfma_f32_16x16x32_bf16 v[84:87], v[218:221], a[116:119], v[84:87]
    v_mfma_f32_16x16x32_bf16 v[84:87], v[222:225], a[120:123], v[84:87]
    v_mfma_f32_16x16x32_bf16 v[84:87], v[226:229], a[124:127], v[84:87]
    s_add_u32 s55, s56, 57344
    buffer_load_dwordx4 v[124:127], v207, s[16:19], s55 offen offset:0 sc1
    v_mfma_f32_16x16x32_bf16 v[84:87], v[230:233], a[128:131], v[84:87]
    v_mfma_f32_16x16x32_bf16 v[84:87], v[234:237], a[132:135], v[84:87]
    v_mfma_f32_16x16x32_bf16 v[84:87], v[238:241], a[136:139], v[84:87]
    v_mfma_f32_16x16x32_bf16 v[88:91], v[210:213], a[112:115], v[88:91]
    ds_read_b128 a[112:115], v198 offset:2432
    v_mfma_f32_16x16x32_bf16 v[88:91], v[214:217], a[116:119], v[88:91]
    v_mfma_f32_16x16x32_bf16 v[88:91], v[218:221], a[120:123], v[88:91]
    v_mfma_f32_16x16x32_bf16 v[88:91], v[222:225], a[124:127], v[88:91]
    buffer_load_dwordx4 v[128:131], v207, s[16:19], s55 offen offset:1024 sc1
    v_mfma_f32_16x16x32_bf16 v[88:91], v[226:229], a[128:131], v[88:91]
    v_mfma_f32_16x16x32_bf16 v[88:91], v[230:233], a[132:135], v[88:91]
    v_mfma_f32_16x16x32_bf16 v[88:91], v[234:237], a[136:139], v[88:91]
    v_mfma_f32_16x16x32_bf16 v[88:91], v[238:241], a[140:143], v[88:91]
    v_mfma_f32_16x16x32_bf16 v[92:95], v[210:213], a[116:119], v[92:95]
    ds_read_b128 a[116:119], v198 offset:3008
    v_mfma_f32_16x16x32_bf16 v[92:95], v[214:217], a[120:123], v[92:95]
    v_mfma_f32_16x16x32_bf16 v[92:95], v[218:221], a[124:127], v[92:95]
    buffer_load_dwordx4 v[132:135], v207, s[16:19], s55 offen offset:2048 sc1
    v_mfma_f32_16x16x32_bf16 v[92:95], v[222:225], a[128:131], v[92:95]
    v_mfma_f32_16x16x32_bf16 v[92:95], v[226:229], a[132:135], v[92:95]
    v_mfma_f32_16x16x32_bf16 v[92:95], v[230:233], a[136:139], v[92:95]
    v_mfma_f32_16x16x32_bf16 v[92:95], v[234:237], a[140:143], v[92:95]
    v_mfma_f32_16x16x32_bf16 v[92:95], v[238:241], a[144:147], v[92:95]
    v_mfma_f32_16x16x32_bf16 v[96:99], v[210:213], a[120:123], v[96:99]
    ds_read_b128 a[120:123], v198 offset:3584
    v_mfma_f32_16x16x32_bf16 v[96:99], v[214:217], a[124:127], v[96:99]
    buffer_load_dwordx4 v[136:139], v207, s[16:19], s55 offen offset:3072 sc1
    v_mfma_f32_16x16x32_bf16 v[96:99], v[218:221], a[128:131], v[96:99]
    v_mfma_f32_16x16x32_bf16 v[96:99], v[222:225], a[132:135], v[96:99]
    v_mfma_f32_16x16x32_bf16 v[96:99], v[226:229], a[136:139], v[96:99]
    v_mfma_f32_16x16x32_bf16 v[96:99], v[230:233], a[140:143], v[96:99]
    v_mfma_f32_16x16x32_bf16 v[96:99], v[234:237], a[144:147], v[96:99]
    v_mfma_f32_16x16x32_bf16 v[96:99], v[238:241], a[148:151], v[96:99]
    v_mfma_f32_16x16x32_bf16 v[100:103], v[210:213], a[124:127], v[100:103]
    s_add_u32 s55, s56, 12288
    buffer_load_dwordx4 a[224:227], v207, s[16:19], s55 offen offset:0 sc1
    v_mfma_f32_16x16x32_bf16 v[100:103], v[214:217], a[128:131], v[100:103]
    ds_read_b128 a[124:127], v198 offset:4160
    v_mfma_f32_16x16x32_bf16 v[100:103], v[218:221], a[132:135], v[100:103]
    v_mfma_f32_16x16x32_bf16 v[100:103], v[222:225], a[136:139], v[100:103]
    v_mfma_f32_16x16x32_bf16 v[100:103], v[226:229], a[140:143], v[100:103]
    v_mfma_f32_16x16x32_bf16 v[100:103], v[230:233], a[144:147], v[100:103]
    v_mfma_f32_16x16x32_bf16 v[100:103], v[234:237], a[148:151], v[100:103]
    v_mfma_f32_16x16x32_bf16 v[100:103], v[238:241], a[152:155], v[100:103]
    buffer_load_dwordx4 a[228:231], v207, s[16:19], s55 offen offset:1024 sc1
    v_mfma_f32_16x16x32_bf16 v[104:107], v[210:213], a[128:131], v[104:107]
    ds_read_b128 a[128:131], v198 offset:4736
    v_mfma_f32_16x16x32_bf16 v[104:107], v[214:217], a[132:135], v[104:107]
    v_mfma_f32_16x16x32_bf16 v[104:107], v[218:221], a[136:139], v[104:107]
    ds_read_b128 a[132:135], v198 offset:5312
    v_mfma_f32_16x16x32_bf16 v[104:107], v[222:225], a[140:143], v[104:107]
    v_mfma_f32_16x16x32_bf16 v[104:107], v[226:229], a[144:147], v[104:107]
    ds_read_b128 a[136:139], v198 offset:5888
    v_mfma_f32_16x16x32_bf16 v[104:107], v[230:233], a[148:151], v[104:107]
    v_mfma_f32_16x16x32_bf16 v[104:107], v[234:237], a[152:155], v[104:107]
    buffer_load_dwordx4 a[232:235], v207, s[16:19], s55 offen offset:2048 sc1
    ds_read_b128 a[140:143], v198 offset:6464
    v_mfma_f32_16x16x32_bf16 v[104:107], v[238:241], a[156:159], v[104:107]
    v_mfma_f32_16x16x32_bf16 v[0:3], a[192:195], a[32:35], v[0:3]
    ds_read_b128 a[144:147], v198 offset:7040
    s_waitcnt vmcnt(13) lgkmcnt(6)
    v_mfma_f32_16x16x32_bf16 v[0:3], a[196:199], a[36:39], v[0:3]
    s_waitcnt vmcnt(12)
    v_mfma_f32_16x16x32_bf16 v[0:3], a[200:203], a[40:43], v[0:3]
    ds_read_b128 a[148:151], v198 offset:7616
    s_waitcnt vmcnt(11)
    v_mfma_f32_16x16x32_bf16 v[0:3], a[204:207], a[44:47], v[0:3]
    v_mfma_f32_16x16x32_bf16 v[4:7], a[192:195], a[36:39], v[4:7]
    ds_read_b128 a[152:155], v198 offset:8192
    v_mfma_f32_16x16x32_bf16 v[4:7], a[196:199], a[40:43], v[4:7]
    buffer_load_dwordx4 a[236:239], v207, s[16:19], s55 offen offset:3072 sc1
    v_mfma_f32_16x16x32_bf16 v[4:7], a[200:203], a[44:47], v[4:7]
    ds_read_b128 a[156:159], v198 offset:8768
    v_mfma_f32_16x16x32_bf16 v[4:7], a[204:207], a[48:51], v[4:7]
    v_mfma_f32_16x16x32_bf16 v[8:11], a[192:195], a[40:43], v[8:11]
    ds_read_b128 a[0:3], v197 offset:64
    v_mfma_f32_16x16x32_bf16 v[8:11], a[196:199], a[44:47], v[8:11]
    v_mfma_f32_16x16x32_bf16 v[8:11], a[200:203], a[48:51], v[8:11]
    ds_read_b128 a[4:7], v197 offset:640
    v_mfma_f32_16x16x32_bf16 v[8:11], a[204:207], a[52:55], v[8:11]
    v_mfma_f32_16x16x32_bf16 v[12:15], a[192:195], a[44:47], v[12:15]
    s_add_u32 s55, s56, 16384
    buffer_load_dwordx4 a[240:243], v207, s[16:19], s55 offen offset:0 sc1
    v_mfma_f32_16x16x32_bf16 v[12:15], a[196:199], a[48:51], v[12:15]
    ds_read_b128 a[8:11], v197 offset:1216
    v_mfma_f32_16x16x32_bf16 v[12:15], a[200:203], a[52:55], v[12:15]
    ds_read_b128 a[12:15], v197 offset:1792
    v_mfma_f32_16x16x32_bf16 v[12:15], a[204:207], a[56:59], v[12:15]
    v_mfma_f32_16x16x32_bf16 v[16:19], a[192:195], a[48:51], v[16:19]
    ds_read_b128 a[16:19], v197 offset:2368
    v_mfma_f32_16x16x32_bf16 v[16:19], a[196:199], a[52:55], v[16:19]
    v_mfma_f32_16x16x32_bf16 v[16:19], a[200:203], a[56:59], v[16:19]
    ds_read_b128 a[20:23], v197 offset:2944
    v_mfma_f32_16x16x32_bf16 v[16:19], a[204:207], a[60:63], v[16:19]
    buffer_load_dwordx4 a[244:247], v207, s[16:19], s55 offen offset:1024 sc1
    v_mfma_f32_16x16x32_bf16 v[20:23], a[192:195], a[52:55], v[20:23]
    ds_read_b128 a[24:27], v197 offset:3520
    v_mfma_f32_16x16x32_bf16 v[20:23], a[196:199], a[56:59], v[20:23]
    v_mfma_f32_16x16x32_bf16 v[20:23], a[200:203], a[60:63], v[20:23]
    ds_read_b128 a[28:31], v197 offset:4096
    v_mfma_f32_16x16x32_bf16 v[20:23], a[204:207], a[64:67], v[20:23]
    v_mfma_f32_16x16x32_bf16 v[24:27], a[192:195], a[56:59], v[24:27]
    ds_read_b128 a[32:35], v197 offset:4672
    v_mfma_f32_16x16x32_bf16 v[24:27], a[196:199], a[60:63], v[24:27]
    v_mfma_f32_16x16x32_bf16 v[24:27], a[200:203], a[64:67], v[24:27]
    buffer_load_dwordx4 a[248:251], v207, s[16:19], s55 offen offset:2048 sc1
    ds_read_b128 a[36:39], v197 offset:5248
    v_mfma_f32_16x16x32_bf16 v[24:27], a[204:207], a[68:71], v[24:27]
    v_mfma_f32_16x16x32_bf16 v[28:31], a[192:195], a[60:63], v[28:31]
    ds_read_b128 a[40:43], v197 offset:5824
    v_mfma_f32_16x16x32_bf16 v[28:31], a[196:199], a[64:67], v[28:31]
    v_mfma_f32_16x16x32_bf16 v[28:31], a[200:203], a[68:71], v[28:31]
    ds_read_b128 a[44:47], v197 offset:6400
    v_mfma_f32_16x16x32_bf16 v[28:31], a[204:207], a[72:75], v[28:31]
    v_mfma_f32_16x16x32_bf16 v[32:35], a[192:195], a[64:67], v[32:35]
    ds_read_b128 a[48:51], v197 offset:6976
    v_mfma_f32_16x16x32_bf16 v[32:35], a[196:199], a[68:71], v[32:35]
    buffer_load_dwordx4 a[252:255], v207, s[16:19], s55 offen offset:3072 sc1
    v_mfma_f32_16x16x32_bf16 v[32:35], a[200:203], a[72:75], v[32:35]
    ds_read_b128 a[52:55], v197 offset:7552
    v_mfma_f32_16x16x32_bf16 v[32:35], a[204:207], a[76:79], v[32:35]
    s_waitcnt vmcnt(13) lgkmcnt(9)
    v_mfma_f32_16x16x32_bf16 v[72:75], v[108:111], a[96:99], v[72:75]
    ds_read_b128 a[56:59], v197 offset:8128
    v_mfma_f32_16x16x32_bf16 v[72:75], v[112:115], a[100:103], v[72:75]
    v_mfma_f32_16x16x32_bf16 v[72:75], v[116:119], a[104:107], v[72:75]
    ds_read_b128 a[60:63], v197 offset:8704
    s_waitcnt vmcnt(12) lgkmcnt(9)
    v_mfma_f32_16x16x32_bf16 v[72:75], v[120:123], a[108:111], v[72:75]
    s_waitcnt vmcnt(11)
    v_mfma_f32_16x16x32_bf16 v[72:75], v[124:127], a[112:115], v[72:75]
    s_add_u32 s55, s56, 77824
    buffer_load_dwordx4 v[210:213], v207, s[16:19], s55 offen offset:0 sc1
    s_waitcnt vmcnt(11) lgkmcnt(8)
    v_mfma_f32_16x16x32_bf16 v[72:75], v[128:131], a[116:119], v[72:75]
    ds_read_b128 a[96:99], v198 offset:192
    s_waitcnt vmcnt(10)
    v_mfma_f32_16x16x32_bf16 v[72:75], v[132:135], a[120:123], v[72:75]
    s_waitcnt vmcnt(9) lgkmcnt(8)
    v_mfma_f32_16x16x32_bf16 v[72:75], v[136:139], a[124:127], v[72:75]
    v_mfma_f32_16x16x32_bf16 v[76:79], v[108:111], a[100:103], v[76:79]
    ds_read_b128 a[100:103], v198 offset:768
    v_mfma_f32_16x16x32_bf16 v[76:79], v[112:115], a[104:107], v[76:79]
    v_mfma_f32_16x16x32_bf16 v[76:79], v[116:119], a[108:111], v[76:79]
    v_mfma_f32_16x16x32_bf16 v[76:79], v[120:123], a[112:115], v[76:79]
    buffer_load_dwordx4 v[214:217], v207, s[16:19], s55 offen offset:1024 sc1
    v_mfma_f32_16x16x32_bf16 v[76:79], v[124:127], a[116:119], v[76:79]
    v_mfma_f32_16x16x32_bf16 v[76:79], v[128:131], a[120:123], v[76:79]
    v_mfma_f32_16x16x32_bf16 v[76:79], v[132:135], a[124:127], v[76:79]
    v_mfma_f32_16x16x32_bf16 v[76:79], v[136:139], a[128:131], v[76:79]
    v_mfma_f32_16x16x32_bf16 v[80:83], v[108:111], a[104:107], v[80:83]
    ds_read_b128 a[104:107], v198 offset:1344
    v_mfma_f32_16x16x32_bf16 v[80:83], v[112:115], a[108:111], v[80:83]
    v_mfma_f32_16x16x32_bf16 v[80:83], v[116:119], a[112:115], v[80:83]
    buffer_load_dwordx4 v[218:221], v207, s[16:19], s55 offen offset:2048 sc1
    v_mfma_f32_16x16x32_bf16 v[80:83], v[120:123], a[116:119], v[80:83]
    v_mfma_f32_16x16x32_bf16 v[80:83], v[124:127], a[120:123], v[80:83]
    v_mfma_f32_16x16x32_bf16 v[80:83], v[128:131], a[124:127], v[80:83]
    v_mfma_f32_16x16x32_bf16 v[80:83], v[132:135], a[128:131], v[80:83]
    v_mfma_f32_16x16x32_bf16 v[80:83], v[136:139], a[132:135], v[80:83]
    v_mfma_f32_16x16x32_bf16 v[84:87], v[108:111], a[108:111], v[84:87]
    ds_read_b128 a[108:111], v198 offset:1920
    v_mfma_f32_16x16x32_bf16 v[84:87], v[112:115], a[112:115], v[84:87]
    buffer_load_dwordx4 v[222:225], v207, s[16:19], s55 offen offset:3072 sc1
    v_mfma_f32_16x16x32_bf16 v[84:87], v[116:119], a[116:119], v[84:87]
    v_mfma_f32_16x16x32_bf16 v[84:87], v[120:123], a[120:123], v[84:87]
    v_mfma_f32_16x16x32_bf16 v[84:87], v[124:127], a[124:127], v[84:87]
    v_mfma_f32_16x16x32_bf16 v[84:87], v[128:131], a[128:131], v[84:87]
    v_mfma_f32_16x16x32_bf16 v[84:87], v[132:135], a[132:135], v[84:87]
    s_add_u32 s55, s56, 81920
    buffer_load_dwordx4 v[226:229], v207, s[16:19], s55 offen offset:0 sc1
    v_mfma_f32_16x16x32_bf16 v[84:87], v[136:139], a[136:139], v[84:87]
    v_mfma_f32_16x16x32_bf16 v[88:91], v[108:111], a[112:115], v[88:91]
    ds_read_b128 a[112:115], v198 offset:2496
    v_mfma_f32_16x16x32_bf16 v[88:91], v[112:115], a[116:119], v[88:91]
    v_mfma_f32_16x16x32_bf16 v[88:91], v[116:119], a[120:123], v[88:91]
    v_mfma_f32_16x16x32_bf16 v[88:91], v[120:123], a[124:127], v[88:91]
    buffer_load_dwordx4 v[230:233], v207, s[16:19], s55 offen offset:1024 sc1
    v_mfma_f32_16x16x32_bf16 v[88:91], v[124:127], a[128:131], v[88:91]
    v_mfma_f32_16x16x32_bf16 v[88:91], v[128:131], a[132:135], v[88:91]
    v_mfma_f32_16x16x32_bf16 v[88:91], v[132:135], a[136:139], v[88:91]
    v_mfma_f32_16x16x32_bf16 v[88:91], v[136:139], a[140:143], v[88:91]
    v_mfma_f32_16x16x32_bf16 v[92:95], v[108:111], a[116:119], v[92:95]
    buffer_load_dwordx4 v[234:237], v207, s[16:19], s55 offen offset:2048 sc1
    ds_read_b128 a[116:119], v198 offset:3072
    v_mfma_f32_16x16x32_bf16 v[92:95], v[112:115], a[120:123], v[92:95]
    v_mfma_f32_16x16x32_bf16 v[92:95], v[116:119], a[124:127], v[92:95]
    v_mfma_f32_16x16x32_bf16 v[92:95], v[120:123], a[128:131], v[92:95]
    v_mfma_f32_16x16x32_bf16 v[92:95], v[124:127], a[132:135], v[92:95]
    v_mfma_f32_16x16x32_bf16 v[92:95], v[128:131], a[136:139], v[92:95]
    buffer_load_dwordx4 v[238:241], v207, s[16:19], s55 offen offset:3072 sc1
    v_mfma_f32_16x16x32_bf16 v[92:95], v[132:135], a[140:143], v[92:95]
    v_mfma_f32_16x16x32_bf16 v[92:95], v[136:139], a[144:147], v[92:95]
    v_mfma_f32_16x16x32_bf16 v[96:99], v[108:111], a[120:123], v[96:99]
    ds_read_b128 a[120:123], v198 offset:3648
    v_mfma_f32_16x16x32_bf16 v[96:99], v[112:115], a[124:127], v[96:99]
    v_mfma_f32_16x16x32_bf16 v[96:99], v[116:119], a[128:131], v[96:99]
    s_add_u32 s55, s56, 20480
    buffer_load_dwordx4 v[140:143], v207, s[16:19], s55 offen offset:0 sc1
    v_mfma_f32_16x16x32_bf16 v[96:99], v[120:123], a[132:135], v[96:99]
    v_mfma_f32_16x16x32_bf16 v[96:99], v[124:127], a[136:139], v[96:99]
    v_mfma_f32_16x16x32_bf16 v[96:99], v[128:131], a[140:143], v[96:99]
    v_mfma_f32_16x16x32_bf16 v[96:99], v[132:135], a[144:147], v[96:99]
    v_mfma_f32_16x16x32_bf16 v[96:99], v[136:139], a[148:151], v[96:99]
    buffer_load_dwordx4 v[144:147], v207, s[16:19], s55 offen offset:1024 sc1
    v_mfma_f32_16x16x32_bf16 v[100:103], v[108:111], a[124:127], v[100:103]
    ds_read_b128 a[124:127], v198 offset:4224
    v_mfma_f32_16x16x32_bf16 v[100:103], v[112:115], a[128:131], v[100:103]
    v_mfma_f32_16x16x32_bf16 v[100:103], v[116:119], a[132:135], v[100:103]
    v_mfma_f32_16x16x32_bf16 v[100:103], v[120:123], a[136:139], v[100:103]
    v_mfma_f32_16x16x32_bf16 v[100:103], v[124:127], a[140:143], v[100:103]
    buffer_load_dwordx4 v[148:151], v207, s[16:19], s55 offen offset:2048 sc1
    v_mfma_f32_16x16x32_bf16 v[100:103], v[128:131], a[144:147], v[100:103]
    v_mfma_f32_16x16x32_bf16 v[100:103], v[132:135], a[148:151], v[100:103]
    v_mfma_f32_16x16x32_bf16 v[100:103], v[136:139], a[152:155], v[100:103]
    v_mfma_f32_16x16x32_bf16 v[104:107], v[108:111], a[128:131], v[104:107]
    ds_read_b128 a[128:131], v198 offset:4800
    v_mfma_f32_16x16x32_bf16 v[104:107], v[112:115], a[132:135], v[104:107]
    buffer_load_dwordx4 v[152:155], v207, s[16:19], s55 offen offset:3072 sc1
    v_mfma_f32_16x16x32_bf16 v[104:107], v[116:119], a[136:139], v[104:107]
    ds_read_b128 a[132:135], v198 offset:5376
    v_mfma_f32_16x16x32_bf16 v[104:107], v[120:123], a[140:143], v[104:107]
    v_mfma_f32_16x16x32_bf16 v[104:107], v[124:127], a[144:147], v[104:107]
    ds_read_b128 a[136:139], v198 offset:5952
    v_mfma_f32_16x16x32_bf16 v[104:107], v[128:131], a[148:151], v[104:107]
    v_mfma_f32_16x16x32_bf16 v[104:107], v[132:135], a[152:155], v[104:107]
    s_add_u32 s55, s56, 24576
    buffer_load_dwordx4 v[156:159], v207, s[16:19], s55 offen offset:0 sc1
    v_mfma_f32_16x16x32_bf16 v[104:107], v[136:139], a[156:159], v[104:107]
    ds_read_b128 a[140:143], v198 offset:6528
    s_waitcnt vmcnt(16) lgkmcnt(5)
    v_mfma_f32_16x16x32_bf16 v[0:3], a[224:227], a[0:3], v[0:3]
    ds_read_b128 a[144:147], v198 offset:7104
    v_mfma_f32_16x16x32_bf16 v[0:3], a[228:231], a[4:7], v[0:3]
    v_mfma_f32_16x16x32_bf16 v[0:3], a[232:235], a[8:11], v[0:3]
    ds_read_b128 a[148:151], v198 offset:7680
    v_mfma_f32_16x16x32_bf16 v[0:3], a[236:239], a[12:15], v[0:3]
    buffer_load_dwordx4 v[160:163], v207, s[16:19], s55 offen offset:1024 sc1
    v_mfma_f32_16x16x32_bf16 v[0:3], a[240:243], a[16:19], v[0:3]
    ds_read_b128 a[152:155], v198 offset:8256
    s_waitcnt vmcnt(16) lgkmcnt(7)
    v_mfma_f32_16x16x32_bf16 v[0:3], a[244:247], a[20:23], v[0:3]
    s_waitcnt vmcnt(15)
    v_mfma_f32_16x16x32_bf16 v[0:3], a[248:251], a[24:27], v[0:3]
    ds_read_b128 a[156:159], v198 offset:8832
    s_waitcnt vmcnt(14)
    v_mfma_f32_16x16x32_bf16 v[0:3], a[252:255], a[28:31], v[0:3]
    v_mfma_f32_16x16x32_bf16 v[4:7], a[224:227], a[4:7], v[4:7]
    buffer_load_dwordx4 v[164:167], v207, s[16:19], s55 offen offset:2048 sc1
    ds_read_b128 a[64:67], v197 offset:9280
    v_mfma_f32_16x16x32_bf16 v[4:7], a[228:231], a[8:11], v[4:7]
    v_mfma_f32_16x16x32_bf16 v[4:7], a[232:235], a[12:15], v[4:7]
    ds_read_b128 a[68:71], v197 offset:9856
    v_mfma_f32_16x16x32_bf16 v[4:7], a[236:239], a[16:19], v[4:7]
    v_mfma_f32_16x16x32_bf16 v[4:7], a[240:243], a[20:23], v[4:7]
    ds_read_b128 a[72:75], v197 offset:10432
    v_mfma_f32_16x16x32_bf16 v[4:7], a[244:247], a[24:27], v[4:7]
    buffer_load_dwordx4 v[168:171], v207, s[16:19], s55 offen offset:3072 sc1
    v_mfma_f32_16x16x32_bf16 v[4:7], a[248:251], a[28:31], v[4:7]
    ds_read_b128 a[76:79], v197 offset:11008
    v_mfma_f32_16x16x32_bf16 v[4:7], a[252:255], a[32:35], v[4:7]
    v_mfma_f32_16x16x32_bf16 v[8:11], a[224:227], a[8:11], v[8:11]
    ds_read_b128 a[80:83], v197 offset:11584
    v_mfma_f32_16x16x32_bf16 v[8:11], a[228:231], a[12:15], v[8:11]
    v_mfma_f32_16x16x32_bf16 v[8:11], a[232:235], a[16:19], v[8:11]
    s_add_u32 s55, s56, 45056
    buffer_load_dwordx4 a[192:195], v207, s[16:19], s55 offen offset:0 sc1
    v_mfma_f32_16x16x32_bf16 v[8:11], a[236:239], a[20:23], v[8:11]
    ds_read_b128 a[84:87], v197 offset:12160
    v_mfma_f32_16x16x32_bf16 v[8:11], a[240:243], a[24:27], v[8:11]
    ds_read_b128 a[88:91], v197 offset:12736
    v_mfma_f32_16x16x32_bf16 v[8:11], a[244:247], a[28:31], v[8:11]
    v_mfma_f32_16x16x32_bf16 v[8:11], a[248:251], a[32:35], v[8:11]
    ds_read_b128 a[92:95], v197 offset:13312
    v_mfma_f32_16x16x32_bf16 v[8:11], a[252:255], a[36:39], v[8:11]
    buffer_load_dwordx4 a[196:199], v207, s[16:19], s55 offen offset:1024 sc1
    v_mfma_f32_16x16x32_bf16 v[12:15], a[224:227], a[12:15], v[12:15]
    ds_read_b128 a[0:3], v197 offset:128
    v_mfma_f32_16x16x32_bf16 v[12:15], a[228:231], a[16:19], v[12:15]
    v_mfma_f32_16x16x32_bf16 v[12:15], a[232:235], a[20:23], v[12:15]
    ds_read_b128 a[4:7], v197 offset:704
    v_mfma_f32_16x16x32_bf16 v[12:15], a[236:239], a[24:27], v[12:15]
    v_mfma_f32_16x16x32_bf16 v[12:15], a[240:243], a[28:31], v[12:15]
    buffer_load_dwordx4 a[200:203], v207, s[16:19], s55 offen offset:2048 sc1
    ds_read_b128 a[8:11], v197 offset:1280
    v_mfma_f32_16x16x32_bf16 v[12:15], a[244:247], a[32:35], v[12:15]
    v_mfma_f32_16x16x32_bf16 v[12:15], a[248:251], a[36:39], v[12:15]
    ds_read_b128 a[12:15], v197 offset:1856
    v_mfma_f32_16x16x32_bf16 v[12:15], a[252:255], a[40:43], v[12:15]
    v_mfma_f32_16x16x32_bf16 v[16:19], a[224:227], a[16:19], v[16:19]
    ds_read_b128 a[16:19], v197 offset:2432
    v_mfma_f32_16x16x32_bf16 v[16:19], a[228:231], a[20:23], v[16:19]
    buffer_load_dwordx4 a[204:207], v207, s[16:19], s55 offen offset:3072 sc1
    v_mfma_f32_16x16x32_bf16 v[16:19], a[232:235], a[24:27], v[16:19]
    v_mfma_f32_16x16x32_bf16 v[16:19], a[236:239], a[28:31], v[16:19]
    v_mfma_f32_16x16x32_bf16 v[16:19], a[240:243], a[32:35], v[16:19]
    v_mfma_f32_16x16x32_bf16 v[16:19], a[244:247], a[36:39], v[16:19]
    v_mfma_f32_16x16x32_bf16 v[16:19], a[248:251], a[40:43], v[16:19]
    s_add_u32 s55, s56, 49152
    buffer_load_dwordx4 a[208:211], v207, s[16:19], s55 offen offset:0 sc1
    v_mfma_f32_16x16x32_bf16 v[16:19], a[252:255], a[44:47], v[16:19]
    v_mfma_f32_16x16x32_bf16 v[20:23], a[224:227], a[20:23], v[20:23]
    ds_read_b128 a[20:23], v197 offset:3008
    v_mfma_f32_16x16x32_bf16 v[20:23], a[228:231], a[24:27], v[20:23]
    v_mfma_f32_16x16x32_bf16 v[20:23], a[232:235], a[28:31], v[20:23]
    v_mfma_f32_16x16x32_bf16 v[20:23], a[236:239], a[32:35], v[20:23]
    buffer_load_dwordx4 a[212:215], v207, s[16:19], s55 offen offset:1024 sc1
    v_mfma_f32_16x16x32_bf16 v[20:23], a[240:243], a[36:39], v[20:23]
    v_mfma_f32_16x16x32_bf16 v[20:23], a[244:247], a[40:43], v[20:23]
    v_mfma_f32_16x16x32_bf16 v[20:23], a[248:251], a[44:47], v[20:23]
    v_mfma_f32_16x16x32_bf16 v[20:23], a[252:255], a[48:51], v[20:23]
    v_mfma_f32_16x16x32_bf16 v[24:27], a[224:227], a[24:27], v[24:27]
    buffer_load_dwordx4 a[216:219], v207, s[16:19], s55 offen offset:2048 sc1
    ds_read_b128 a[24:27], v197 offset:3584
    v_mfma_f32_16x16x32_bf16 v[24:27], a[228:231], a[28:31], v[24:27]
    v_mfma_f32_16x16x32_bf16 v[24:27], a[232:235], a[32:35], v[24:27]
    v_mfma_f32_16x16x32_bf16 v[24:27], a[236:239], a[36:39], v[24:27]
    v_mfma_f32_16x16x32_bf16 v[24:27], a[240:243], a[40:43], v[24:27]
    v_mfma_f32_16x16x32_bf16 v[24:27], a[244:247], a[44:47], v[24:27]
    buffer_load_dwordx4 a[220:223], v207, s[16:19], s55 offen offset:3072 sc1
    v_mfma_f32_16x16x32_bf16 v[24:27], a[248:251], a[48:51], v[24:27]
    v_mfma_f32_16x16x32_bf16 v[24:27], a[252:255], a[52:55], v[24:27]
    v_mfma_f32_16x16x32_bf16 v[28:31], a[224:227], a[28:31], v[28:31]
    ds_read_b128 a[28:31], v197 offset:4160
    v_mfma_f32_16x16x32_bf16 v[28:31], a[228:231], a[32:35], v[28:31]
    v_mfma_f32_16x16x32_bf16 v[28:31], a[232:235], a[36:39], v[28:31]
    s_add_u32 s55, s56, 69632
    buffer_load_dwordx4 v[108:111], v207, s[16:19], s55 offen offset:0 sc1
    v_mfma_f32_16x16x32_bf16 v[28:31], a[236:239], a[40:43], v[28:31]
    v_mfma_f32_16x16x32_bf16 v[28:31], a[240:243], a[44:47], v[28:31]
    v_mfma_f32_16x16x32_bf16 v[28:31], a[244:247], a[48:51], v[28:31]
    v_mfma_f32_16x16x32_bf16 v[28:31], a[248:251], a[52:55], v[28:31]
    v_mfma_f32_16x16x32_bf16 v[28:31], a[252:255], a[56:59], v[28:31]
    buffer_load_dwordx4 v[112:115], v207, s[16:19], s55 offen offset:1024 sc1
    v_mfma_f32_16x16x32_bf16 v[32:35], a[224:227], a[32:35], v[32:35]
    v_mfma_f32_16x16x32_bf16 v[32:35], a[228:231], a[36:39], v[32:35]
    v_mfma_f32_16x16x32_bf16 v[32:35], a[232:235], a[40:43], v[32:35]
    v_mfma_f32_16x16x32_bf16 v[32:35], a[236:239], a[44:47], v[32:35]
    v_mfma_f32_16x16x32_bf16 v[32:35], a[240:243], a[48:51], v[32:35]
    s_add_u32 s55, s56, 36864
    buffer_load_dwordx4 a[224:227], v207, s[16:19], s55 offen offset:0 sc1
    v_mfma_f32_16x16x32_bf16 v[32:35], a[244:247], a[52:55], v[32:35]
    v_mfma_f32_16x16x32_bf16 v[32:35], a[248:251], a[56:59], v[32:35]
    v_mfma_f32_16x16x32_bf16 v[32:35], a[252:255], a[60:63], v[32:35]
    s_waitcnt vmcnt(18) lgkmcnt(1)
    v_mfma_f32_16x16x32_bf16 v[72:75], v[210:213], a[96:99], v[72:75]
    v_mfma_f32_16x16x32_bf16 v[72:75], v[214:217], a[100:103], v[72:75]
    buffer_load_dwordx4 a[228:231], v207, s[16:19], s55 offen offset:1024 sc1
    v_mfma_f32_16x16x32_bf16 v[72:75], v[218:221], a[104:107], v[72:75]
    v_mfma_f32_16x16x32_bf16 v[72:75], v[222:225], a[108:111], v[72:75]
    v_mfma_f32_16x16x32_bf16 v[72:75], v[226:229], a[112:115], v[72:75]
    s_waitcnt lgkmcnt(0)
    s_barrier
    v_mfma_f32_16x16x32_bf16 v[72:75], v[230:233], a[116:119], v[72:75]
    v_mfma_f32_16x16x32_bf16 v[72:75], v[234:237], a[120:123], v[72:75]
    buffer_load_dwordx4 a[232:235], v207, s[16:19], s55 offen offset:2048 sc1
    v_mfma_f32_16x16x32_bf16 v[72:75], v[238:241], a[124:127], v[72:75]
    v_mfma_f32_16x16x32_bf16 v[76:79], v[210:213], a[100:103], v[76:79]
    v_mfma_f32_16x16x32_bf16 v[76:79], v[214:217], a[104:107], v[76:79]
    v_mfma_f32_16x16x32_bf16 v[76:79], v[218:221], a[108:111], v[76:79]
    v_mfma_f32_16x16x32_bf16 v[76:79], v[222:225], a[112:115], v[76:79]
    buffer_load_dwordx4 a[236:239], v207, s[16:19], s55 offen offset:3072 sc1
    v_mfma_f32_16x16x32_bf16 v[76:79], v[226:229], a[116:119], v[76:79]
    s_nop 1
    v_add_f32 v36, v36, v72
    v_add_f32 v37, v37, v73
    v_mfma_f32_16x16x32_bf16 v[76:79], v[230:233], a[120:123], v[76:79]
    v_add_f32 v38, v38, v74
    v_add_f32 v39, v39, v75
    v_mfma_f32_16x16x32_bf16 v[76:79], v[234:237], a[124:127], v[76:79]
    ds_write_b128 v205, v[36:39] offset:0
    v_mfma_f32_16x16x32_bf16 v[76:79], v[238:241], a[128:131], v[76:79]
    v_mfma_f32_16x16x32_bf16 v[80:83], v[210:213], a[104:107], v[80:83]
    s_add_u32 s55, s56, 40960
    buffer_load_dwordx4 a[240:243], v207, s[16:19], s55 offen offset:0 sc1
    v_mfma_f32_16x16x32_bf16 v[80:83], v[214:217], a[108:111], v[80:83]
    v_mfma_f32_16x16x32_bf16 v[80:83], v[218:221], a[112:115], v[80:83]
    v_mfma_f32_16x16x32_bf16 v[80:83], v[222:225], a[116:119], v[80:83]
    v_mfma_f32_16x16x32_bf16 v[80:83], v[226:229], a[120:123], v[80:83]
    s_nop 0
    v_add_f32 v40, v40, v76
    v_add_f32 v41, v41, v77
    v_mfma_f32_16x16x32_bf16 v[80:83], v[230:233], a[124:127], v[80:83]
    v_add_f32 v42, v42, v78
    v_add_f32 v43, v43, v79
    v_mfma_f32_16x16x32_bf16 v[80:83], v[234:237], a[128:131], v[80:83]
    ds_write_b128 v205, v[40:43] offset:1024
    v_mfma_f32_16x16x32_bf16 v[80:83], v[238:241], a[132:135], v[80:83]
    buffer_load_dwordx4 a[244:247], v207, s[16:19], s55 offen offset:1024 sc1
    v_mfma_f32_16x16x32_bf16 v[84:87], v[210:213], a[108:111], v[84:87]
    v_mfma_f32_16x16x32_bf16 v[84:87], v[214:217], a[112:115], v[84:87]
    v_mfma_f32_16x16x32_bf16 v[84:87], v[218:221], a[116:119], v[84:87]
    buffer_load_dwordx4 a[248:251], v207, s[16:19], s55 offen offset:2048 sc1
    v_mfma_f32_16x16x32_bf16 v[84:87], v[222:225], a[120:123], v[84:87]
    v_mfma_f32_16x16x32_bf16 v[84:87], v[226:229], a[124:127], v[84:87]
    s_nop 0
    v_add_f32 v44, v44, v80
    v_add_f32 v45, v45, v81
    v_mfma_f32_16x16x32_bf16 v[84:87], v[230:233], a[128:131], v[84:87]
    v_add_f32 v46, v46, v82
    v_add_f32 v47, v47, v83
    v_mfma_f32_16x16x32_bf16 v[84:87], v[234:237], a[132:135], v[84:87]
    ds_write_b128 v205, v[44:47] offset:2048
    v_mfma_f32_16x16x32_bf16 v[84:87], v[238:241], a[136:139], v[84:87]
    buffer_load_dwordx4 a[252:255], v207, s[16:19], s55 offen offset:3072 sc1
    v_mfma_f32_16x16x32_bf16 v[88:91], v[210:213], a[112:115], v[88:91]
    v_mfma_f32_16x16x32_bf16 v[88:91], v[214:217], a[116:119], v[88:91]
    v_mfma_f32_16x16x32_bf16 v[88:91], v[218:221], a[120:123], v[88:91]
    v_mfma_f32_16x16x32_bf16 v[88:91], v[222:225], a[124:127], v[88:91]
    v_mfma_f32_16x16x32_bf16 v[88:91], v[226:229], a[128:131], v[88:91]
    s_nop 1
    v_add_f32 v48, v48, v84
    v_add_f32 v49, v49, v85
    v_mfma_f32_16x16x32_bf16 v[88:91], v[230:233], a[132:135], v[88:91]
    v_add_f32 v50, v50, v86
    v_add_f32 v51, v51, v87
    v_mfma_f32_16x16x32_bf16 v[88:91], v[234:237], a[136:139], v[88:91]
    ds_write_b128 v205, v[48:51] offset:3072
    v_mfma_f32_16x16x32_bf16 v[88:91], v[238:241], a[140:143], v[88:91]
    s_add_u32 s55, s56, 69632
    buffer_load_dwordx4 v[116:119], v207, s[16:19], s55 offen offset:2048 sc1
    v_mfma_f32_16x16x32_bf16 v[92:95], v[210:213], a[116:119], v[92:95]
    v_mfma_f32_16x16x32_bf16 v[92:95], v[214:217], a[120:123], v[92:95]
    buffer_load_dwordx4 v[120:123], v207, s[16:19], s55 offen offset:3072 sc1
    v_mfma_f32_16x16x32_bf16 v[92:95], v[218:221], a[124:127], v[92:95]
    v_mfma_f32_16x16x32_bf16 v[92:95], v[222:225], a[128:131], v[92:95]
    v_mfma_f32_16x16x32_bf16 v[92:95], v[226:229], a[132:135], v[92:95]
    v_add_f32 v52, v52, v88
    v_add_f32 v53, v53, v89
    v_mfma_f32_16x16x32_bf16 v[92:95], v[230:233], a[136:139], v[92:95]
    v_add_f32 v54, v54, v90
    v_add_f32 v55, v55, v91
    v_mfma_f32_16x16x32_bf16 v[92:95], v[234:237], a[140:143], v[92:95]
    ds_write_b128 v205, v[52:55] offset:4096
    v_mfma_f32_16x16x32_bf16 v[92:95], v[238:241], a[144:147], v[92:95]
    s_add_u32 s55, s56, 73728
    buffer_load_dwordx4 v[124:127], v207, s[16:19], s55 offen offset:0 sc1
    v_mfma_f32_16x16x32_bf16 v[96:99], v[210:213], a[120:123], v[96:99]
    v_mfma_f32_16x16x32_bf16 v[96:99], v[214:217], a[124:127], v[96:99]
    v_mfma_f32_16x16x32_bf16 v[96:99], v[218:221], a[128:131], v[96:99]
    v_mfma_f32_16x16x32_bf16 v[96:99], v[222:225], a[132:135], v[96:99]
    buffer_load_dwordx4 v[128:131], v207, s[16:19], s55 offen offset:1024 sc1
    v_mfma_f32_16x16x32_bf16 v[96:99], v[226:229], a[136:139], v[96:99]
    v_add_f32 v56, v56, v92
    v_add_f32 v57, v57, v93
    v_mfma_f32_16x16x32_bf16 v[96:99], v[230:233], a[140:143], v[96:99]
    v_add_f32 v58, v58, v94
    v_add_f32 v59, v59, v95
    v_mfma_f32_16x16x32_bf16 v[96:99], v[234:237], a[144:147], v[96:99]
    ds_write_b128 v205, v[56:59] offset:5120
    v_mfma_f32_16x16x32_bf16 v[96:99], v[238:241], a[148:151], v[96:99]
    v_mfma_f32_16x16x32_bf16 v[100:103], v[210:213], a[124:127], v[100:103]
    buffer_load_dwordx4 v[132:135], v207, s[16:19], s55 offen offset:2048 sc1
    v_mfma_f32_16x16x32_bf16 v[100:103], v[214:217], a[128:131], v[100:103]
    v_mfma_f32_16x16x32_bf16 v[100:103], v[218:221], a[132:135], v[100:103]
    v_mfma_f32_16x16x32_bf16 v[100:103], v[222:225], a[136:139], v[100:103]
    v_mfma_f32_16x16x32_bf16 v[100:103], v[226:229], a[140:143], v[100:103]
    s_nop 1
    v_add_f32 v60, v60, v96
    v_add_f32 v61, v61, v97
    v_mfma_f32_16x16x32_bf16 v[100:103], v[230:233], a[144:147], v[100:103]
    v_add_f32 v62, v62, v98
    v_add_f32 v63, v63, v99
    v_mfma_f32_16x16x32_bf16 v[100:103], v[234:237], a[148:151], v[100:103]
    ds_write_b128 v205, v[60:63] offset:6144
    v_mfma_f32_16x16x32_bf16 v[100:103], v[238:241], a[152:155], v[100:103]
    buffer_load_dwordx4 v[136:139], v207, s[16:19], s55 offen offset:3072 sc1
    v_mfma_f32_16x16x32_bf16 v[104:107], v[210:213], a[128:131], v[104:107]
    v_mfma_f32_16x16x32_bf16 v[104:107], v[214:217], a[132:135], v[104:107]
    v_mfma_f32_16x16x32_bf16 v[104:107], v[218:221], a[136:139], v[104:107]
    s_add_u32 s55, s56, 61440
    buffer_load_dwordx4 v[210:213], v207, s[16:19], s55 offen offset:0 sc1
    v_mfma_f32_16x16x32_bf16 v[104:107], v[222:225], a[140:143], v[104:107]
    v_mfma_f32_16x16x32_bf16 v[104:107], v[226:229], a[144:147], v[104:107]
    v_add_f32 v64, v64, v100
    v_add_f32 v65, v65, v101
    v_mfma_f32_16x16x32_bf16 v[104:107], v[230:233], a[148:151], v[104:107]
    v_add_f32 v66, v66, v102
    v_add_f32 v67, v67, v103
    v_mfma_f32_16x16x32_bf16 v[104:107], v[234:237], a[152:155], v[104:107]
    ds_write_b128 v205, v[64:67] offset:7168
    v_mfma_f32_16x16x32_bf16 v[104:107], v[238:241], a[156:159], v[104:107]
    buffer_load_dwordx4 v[214:217], v207, s[16:19], s55 offen offset:1024 sc1
    v_mfma_f32_16x16x32_bf16 v[0:3], v[140:143], a[32:35], v[0:3]
    ds_read_b128 a[32:35], v197 offset:4736
    s_waitcnt vmcnt(18) lgkmcnt(3)
    v_mfma_f32_16x16x32_bf16 v[0:3], v[144:147], a[36:39], v[0:3]
    v_mfma_f32_16x16x32_bf16 v[0:3], v[148:151], a[40:43], v[0:3]
    v_mfma_f32_16x16x32_bf16 v[0:3], v[152:155], a[44:47], v[0:3]
    v_mfma_f32_16x16x32_bf16 v[0:3], v[156:159], a[48:51], v[0:3]
    v_add_f32 v68, v68, v104
    v_add_f32 v69, v69, v105
    v_mfma_f32_16x16x32_bf16 v[0:3], v[160:163], a[52:55], v[0:3]
    v_add_f32 v70, v70, v106
    v_add_f32 v71, v71, v107
    v_mfma_f32_16x16x32_bf16 v[0:3], v[164:167], a[56:59], v[0:3]
    ds_write_b128 v205, v[68:71] offset:8192
    v_mfma_f32_16x16x32_bf16 v[0:3], v[168:171], a[60:63], v[0:3]
    buffer_load_dwordx4 v[218:221], v207, s[16:19], s55 offen offset:2048 sc1
    v_mfma_f32_16x16x32_bf16 v[4:7], v[140:143], a[36:39], v[4:7]
    ds_read_b128 a[36:39], v197 offset:5312
    v_mfma_f32_16x16x32_bf16 v[4:7], v[144:147], a[40:43], v[4:7]
    buffer_load_dwordx4 v[222:225], v207, s[16:19], s55 offen offset:3072 sc1
    v_mfma_f32_16x16x32_bf16 v[4:7], v[148:151], a[44:47], v[4:7]
    v_mfma_f32_16x16x32_bf16 v[4:7], v[152:155], a[48:51], v[4:7]
    v_mfma_f32_16x16x32_bf16 v[4:7], v[156:159], a[52:55], v[4:7]
    v_mfma_f32_16x16x32_bf16 v[4:7], v[160:163], a[56:59], v[4:7]
    v_add_f32 v0, v0, v72
    v_add_f32 v1, v1, v73
    v_mfma_f32_16x16x32_bf16 v[4:7], v[164:167], a[60:63], v[4:7]
    s_add_u32 s55, s56, 65536
    buffer_load_dwordx4 v[226:229], v207, s[16:19], s55 offen offset:0 sc1
    v_mfma_f32_16x16x32_bf16 v[4:7], v[168:171], a[64:67], v[4:7]
    v_add_f32 v2, v2, v74
    v_add_f32 v3, v3, v75
    v_mfma_f32_16x16x32_bf16 v[8:11], v[140:143], a[40:43], v[8:11]
    ds_read_b128 a[40:43], v197 offset:5888
    v_mfma_f32_16x16x32_bf16 v[8:11], v[144:147], a[44:47], v[8:11]
    v_mfma_f32_16x16x32_bf16 v[8:11], v[148:151], a[48:51], v[8:11]
    v_mfma_f32_16x16x32_bf16 v[8:11], v[152:155], a[52:55], v[8:11]
    buffer_load_dwordx4 v[230:233], v207, s[16:19], s55 offen offset:1024 sc1
    v_mfma_f32_16x16x32_bf16 v[8:11], v[156:159], a[56:59], v[8:11]
    s_waitcnt lgkmcnt(0)
    s_barrier
    v_mfma_f32_16x16x32_bf16 v[8:11], v[160:163], a[60:63], v[8:11]
    ds_read_b128 v[36:39], v249 offset:0
    v_add_f32 v4, v4, v76
    v_mfma_f32_16x16x32_bf16 v[8:11], v[164:167], a[64:67], v[8:11]
    v_add_f32 v5, v5, v77
    v_add_f32 v6, v6, v78
    v_mfma_f32_16x16x32_bf16 v[8:11], v[168:171], a[68:71], v[8:11]
    ds_read_b128 v[40:43], v249 offset:1024
    v_add_f32 v7, v7, v79
    v_mfma_f32_16x16x32_bf16 v[12:15], v[140:143], a[44:47], v[12:15]
    buffer_load_dwordx4 v[234:237], v207, s[16:19], s55 offen offset:2048 sc1
    ds_read_b128 a[44:47], v197 offset:6464
    v_mfma_f32_16x16x32_bf16 v[12:15], v[144:147], a[48:51], v[12:15]
    ds_read_b128 v[44:47], v249 offset:2048
    v_mfma_f32_16x16x32_bf16 v[12:15], v[148:151], a[52:55], v[12:15]
    v_mfma_f32_16x16x32_bf16 v[12:15], v[152:155], a[56:59], v[12:15]
    ds_read_b128 v[48:51], v249 offset:3072
    v_mfma_f32_16x16x32_bf16 v[12:15], v[156:159], a[60:63], v[12:15]
    v_mfma_f32_16x16x32_bf16 v[12:15], v[160:163], a[64:67], v[12:15]
    ds_read_b128 v[52:55], v249 offset:4096
    buffer_load_dwordx4 v[238:241], v207, s[16:19], s55 offen offset:3072 sc1
    v_mfma_f32_16x16x32_bf16 v[12:15], v[164:167], a[68:71], v[12:15]
    v_add_f32 v8, v8, v80
    v_add_f32 v9, v9, v81
    v_mfma_f32_16x16x32_bf16 v[12:15], v[168:171], a[72:75], v[12:15]
    ds_read_b128 v[56:59], v249 offset:5120
    v_add_f32 v10, v10, v82
    v_mfma_f32_16x16x32_bf16 v[16:19], v[140:143], a[48:51], v[16:19]
    ds_read_b128 a[48:51], v197 offset:7040
    v_add_f32 v11, v11, v83
    v_mfma_f32_16x16x32_bf16 v[16:19], v[144:147], a[52:55], v[16:19]
    ds_read_b128 v[60:63], v249 offset:6144
    v_mfma_f32_16x16x32_bf16 v[16:19], v[148:151], a[56:59], v[16:19]
    s_waitcnt vmcnt(17) lgkmcnt(8)
    v_add_f32 v0, v0, v36
    v_add_f32 v1, v1, v37
    v_mfma_f32_16x16x32_bf16 v[16:19], v[152:155], a[60:63], v[16:19]
    ds_read_b128 v[64:67], v249 offset:7168
    v_add_f32 v2, v2, v38
    v_mfma_f32_16x16x32_bf16 v[16:19], v[156:159], a[64:67], v[16:19]
    v_add_f32 v3, v3, v39
    v_mfma_f32_16x16x32_bf16 v[16:19], v[160:163], a[68:71], v[16:19]
    ds_read_b128 v[68:71], v249 offset:8192
    v_add_f32 v12, v12, v84
    v_mfma_f32_16x16x32_bf16 v[16:19], v[164:167], a[72:75], v[16:19]
    v_add_f32 v13, v13, v85
    v_add_f32 v14, v14, v86
    v_mfma_f32_16x16x32_bf16 v[16:19], v[168:171], a[76:79], v[16:19]
    v_add_f32 v15, v15, v87
    v_mfma_f32_16x16x32_bf16 v[20:23], v[140:143], a[52:55], v[20:23]
    ds_read_b128 a[52:55], v197 offset:7616
    v_mfma_f32_16x16x32_bf16 v[20:23], v[144:147], a[56:59], v[20:23]
    v_mfma_f32_16x16x32_bf16 v[20:23], v[148:151], a[60:63], v[20:23]
    v_mfma_f32_16x16x32_bf16 v[20:23], v[152:155], a[64:67], v[20:23]
    v_mfma_f32_16x16x32_bf16 v[20:23], v[156:159], a[68:71], v[20:23]
    v_mfma_f32_16x16x32_bf16 v[20:23], v[160:163], a[72:75], v[20:23]
    v_add_f32 v16, v16, v88
    v_add_f32 v17, v17, v89
    v_mfma_f32_16x16x32_bf16 v[20:23], v[164:167], a[76:79], v[20:23]
    v_add_f32 v18, v18, v90
    v_add_f32 v19, v19, v91
    v_mfma_f32_16x16x32_bf16 v[20:23], v[168:171], a[80:83], v[20:23]
    v_mfma_f32_16x16x32_bf16 v[24:27], v[140:143], a[56:59], v[24:27]
    ds_read_b128 a[56:59], v197 offset:8192
    v_mfma_f32_16x16x32_bf16 v[24:27], v[144:147], a[60:63], v[24:27]
    v_mfma_f32_16x16x32_bf16 v[24:27], v[148:151], a[64:67], v[24:27]
    s_waitcnt vmcnt(14) lgkmcnt(5)
    v_add_f32 v4, v4, v40
    v_add_f32 v5, v5, v41
    v_mfma_f32_16x16x32_bf16 v[24:27], v[152:155], a[68:71], v[24:27]
    v_add_f32 v6, v6, v42
    v_add_f32 v7, v7, v43
    v_mfma_f32_16x16x32_bf16 v[24:27], v[156:159], a[72:75], v[24:27]
    v_mfma_f32_16x16x32_bf16 v[24:27], v[160:163], a[76:79], v[24:27]
    v_add_f32 v20, v20, v92
    v_add_f32 v21, v21, v93
    v_mfma_f32_16x16x32_bf16 v[24:27], v[164:167], a[80:83], v[24:27]
    v_add_f32 v22, v22, v94
    v_add_f32 v23, v23, v95
    v_mfma_f32_16x16x32_bf16 v[24:27], v[168:171], a[84:87], v[24:27]
    v_mfma_f32_16x16x32_bf16 v[28:31], v[140:143], a[60:63], v[28:31]
    ds_read_b128 a[60:63], v197 offset:8768
    v_add_f32 v8, v8, v44
    v_mfma_f32_16x16x32_bf16 v[28:31], v[144:147], a[64:67], v[28:31]
    v_add_f32 v9, v9, v45
    v_add_f32 v10, v10, v46
    v_mfma_f32_16x16x32_bf16 v[28:31], v[148:151], a[68:71], v[28:31]
    ds_read_b128 a[96:99], v197 offset:192
    v_add_f32 v11, v11, v47
    v_mfma_f32_16x16x32_bf16 v[28:31], v[152:155], a[72:75], v[28:31]
    v_mfma_f32_16x16x32_bf16 v[28:31], v[156:159], a[76:79], v[28:31]
    ds_read_b128 a[100:103], v197 offset:768
    v_mfma_f32_16x16x32_bf16 v[28:31], v[160:163], a[80:83], v[28:31]
    v_add_f32 v24, v24, v96
    v_add_f32 v25, v25, v97
    v_mfma_f32_16x16x32_bf16 v[28:31], v[164:167], a[84:87], v[28:31]
    ds_read_b128 a[104:107], v197 offset:1344
    v_add_f32 v26, v26, v98
    v_mfma_f32_16x16x32_bf16 v[28:31], v[168:171], a[88:91], v[28:31]
    v_add_f32 v27, v27, v99
    v_add_f32 v12, v12, v48
    v_mfma_f32_16x16x32_bf16 v[32:35], v[140:143], a[64:67], v[32:35]
    ds_read_b128 a[108:111], v197 offset:1920
    v_add_f32 v13, v13, v49
    v_mfma_f32_16x16x32_bf16 v[32:35], v[144:147], a[68:71], v[32:35]
    v_add_f32 v14, v14, v50
    v_add_f32 v15, v15, v51
    v_mfma_f32_16x16x32_bf16 v[32:35], v[148:151], a[72:75], v[32:35]
    ds_read_b128 a[112:115], v197 offset:2496
    v_mfma_f32_16x16x32_bf16 v[32:35], v[152:155], a[76:79], v[32:35]
    v_mfma_f32_16x16x32_bf16 v[32:35], v[156:159], a[80:83], v[32:35]
    ds_read_b128 a[116:119], v197 offset:3072
    v_add_f32 v16, v16, v52
    v_mfma_f32_16x16x32_bf16 v[32:35], v[160:163], a[84:87], v[32:35]
    v_add_f32 v28, v28, v100
    v_add_f32 v29, v29, v101
    v_mfma_f32_16x16x32_bf16 v[32:35], v[164:167], a[88:91], v[32:35]
    ds_read_b128 a[120:123], v197 offset:3648
    v_add_f32 v30, v30, v102
    v_mfma_f32_16x16x32_bf16 v[32:35], v[168:171], a[92:95], v[32:35]
    v_add_f32 v31, v31, v103
    v_add_f32 v17, v17, v53
    v_mfma_f32_16x16x32_bf16 v[0:3], a[224:227], a[0:3], v[0:3]
    ds_read_b128 a[124:127], v197 offset:4224
    v_add_f32 v18, v18, v54
    v_mfma_f32_16x16x32_bf16 v[0:3], a[228:231], a[4:7], v[0:3]
    v_add_f32 v19, v19, v55
    v_mfma_f32_16x16x32_bf16 v[0:3], a[232:235], a[8:11], v[0:3]
    ds_read_b128 a[128:131], v197 offset:4800
    v_add_f32 v20, v20, v56
    v_mfma_f32_16x16x32_bf16 v[0:3], a[236:239], a[12:15], v[0:3]
    v_add_f32 v21, v21, v57
    v_add_f32 v22, v22, v58
    v_mfma_f32_16x16x32_bf16 v[0:3], a[240:243], a[16:19], v[0:3]
    ds_read_b128 a[132:135], v197 offset:5376
    v_add_f32 v23, v23, v59
    v_mfma_f32_16x16x32_bf16 v[0:3], a[244:247], a[20:23], v[0:3]
    v_add_f32 v32, v32, v104
    v_add_f32 v33, v33, v105
    v_mfma_f32_16x16x32_bf16 v[0:3], a[248:251], a[24:27], v[0:3]
    ds_read_b128 a[136:139], v197 offset:5952
    v_add_f32 v34, v34, v106
    v_mfma_f32_16x16x32_bf16 v[0:3], a[252:255], a[28:31], v[0:3]
    v_add_f32 v35, v35, v107
    v_mfma_f32_16x16x32_bf16 v[0:3], a[192:195], a[32:35], v[0:3]
    ds_read_b128 a[140:143], v197 offset:6528
    s_waitcnt vmcnt(9) lgkmcnt(9)
    v_add_f32 v24, v24, v60
    v_mfma_f32_16x16x32_bf16 v[0:3], a[196:199], a[36:39], v[0:3]
    v_add_f32 v25, v25, v61
    v_add_f32 v26, v26, v62
    v_mfma_f32_16x16x32_bf16 v[0:3], a[200:203], a[40:43], v[0:3]
    ds_read_b128 a[144:147], v197 offset:7104
    v_add_f32 v27, v27, v63
    v_mfma_f32_16x16x32_bf16 v[0:3], a[204:207], a[44:47], v[0:3]
    v_mfma_f32_16x16x32_bf16 v[0:3], a[208:211], a[48:51], v[0:3]
    ds_read_b128 a[148:151], v197 offset:7680
    v_mfma_f32_16x16x32_bf16 v[0:3], a[212:215], a[52:55], v[0:3]
    v_mfma_f32_16x16x32_bf16 v[0:3], a[216:219], a[56:59], v[0:3]
    ds_read_b128 a[152:155], v197 offset:8256
    v_add_f32 v28, v28, v64
    v_mfma_f32_16x16x32_bf16 v[0:3], a[220:223], a[60:63], v[0:3]
    v_add_f32 v29, v29, v65
    v_add_f32 v30, v30, v66
    s_waitcnt vmcnt(7) lgkmcnt(9)
    v_mfma_f32_16x16x32_bf16 v[0:3], v[210:213], a[96:99], v[0:3]
    ds_read_b128 a[156:159], v197 offset:8832
    v_add_f32 v31, v31, v67
    s_waitcnt vmcnt(6) lgkmcnt(9)
    v_mfma_f32_16x16x32_bf16 v[0:3], v[214:217], a[100:103], v[0:3]
    s_waitcnt vmcnt(5)
    v_mfma_f32_16x16x32_bf16 v[0:3], v[218:221], a[104:107], v[0:3]
    ds_read_b128 a[64:67], v197 offset:9344
    s_waitcnt vmcnt(4) lgkmcnt(9)
    v_mfma_f32_16x16x32_bf16 v[0:3], v[222:225], a[108:111], v[0:3]
    s_waitcnt vmcnt(3)
    v_mfma_f32_16x16x32_bf16 v[0:3], v[226:229], a[112:115], v[0:3]
    ds_read_b128 a[160:163], v197 offset:9408
    v_add_f32 v32, v32, v68
    s_waitcnt vmcnt(2) lgkmcnt(9)
    v_mfma_f32_16x16x32_bf16 v[0:3], v[230:233], a[116:119], v[0:3]
    v_add_f32 v33, v33, v69
    v_add_f32 v34, v34, v70
    s_waitcnt vmcnt(1)
    v_mfma_f32_16x16x32_bf16 v[0:3], v[234:237], a[120:123], v[0:3]
    ds_read_b128 a[68:71], v197 offset:9920
    v_add_f32 v35, v35, v71
    s_waitcnt vmcnt(0) lgkmcnt(9)
    v_mfma_f32_16x16x32_bf16 v[0:3], v[238:241], a[124:127], v[0:3]
    v_mfma_f32_16x16x32_bf16 v[0:3], v[108:111], a[128:131], v[0:3]
    ds_read_b128 a[164:167], v197 offset:9984
    v_mfma_f32_16x16x32_bf16 v[0:3], v[112:115], a[132:135], v[0:3]
    s_waitcnt lgkmcnt(9)
    v_mfma_f32_16x16x32_bf16 v[0:3], v[116:119], a[136:139], v[0:3]
    ds_read_b128 a[72:75], v197 offset:10496
    s_waitcnt lgkmcnt(9)
    v_mfma_f32_16x16x32_bf16 v[0:3], v[120:123], a[140:143], v[0:3]
    s_waitcnt lgkmcnt(8)
    v_mfma_f32_16x16x32_bf16 v[0:3], v[124:127], a[144:147], v[0:3]
    ds_read_b128 a[168:171], v197 offset:10560
    s_waitcnt lgkmcnt(8)
    v_mfma_f32_16x16x32_bf16 v[0:3], v[128:131], a[148:151], v[0:3]
    s_waitcnt lgkmcnt(7)
    v_mfma_f32_16x16x32_bf16 v[0:3], v[132:135], a[152:155], v[0:3]
    ds_read_b128 a[76:79], v197 offset:11072
    s_waitcnt lgkmcnt(7)
    v_mfma_f32_16x16x32_bf16 v[0:3], v[136:139], a[156:159], v[0:3]
    v_mfma_f32_16x16x32_bf16 v[4:7], a[224:227], a[4:7], v[4:7]
    ds_read_b128 a[172:175], v197 offset:11136
    v_mfma_f32_16x16x32_bf16 v[4:7], a[228:231], a[8:11], v[4:7]
    v_mfma_f32_16x16x32_bf16 v[4:7], a[232:235], a[12:15], v[4:7]
    ds_read_b128 a[80:83], v197 offset:11648
    v_mfma_f32_16x16x32_bf16 v[4:7], a[236:239], a[16:19], v[4:7]
    v_mfma_f32_16x16x32_bf16 v[4:7], a[240:243], a[20:23], v[4:7]
    ds_read_b128 a[176:179], v197 offset:11712
    v_mfma_f32_16x16x32_bf16 v[4:7], a[244:247], a[24:27], v[4:7]
    v_mul_f32 v0, s48, v0
    v_mfma_f32_16x16x32_bf16 v[4:7], a[248:251], a[28:31], v[4:7]
    ds_read_b128 a[84:87], v197 offset:12224
    v_mul_f32 v1, s48, v1
    v_mfma_f32_16x16x32_bf16 v[4:7], a[252:255], a[32:35], v[4:7]
    v_mul_f32 v2, s48, v2
    v_mfma_f32_16x16x32_bf16 v[4:7], a[192:195], a[36:39], v[4:7]
    ds_read_b128 a[180:183], v197 offset:12288
    v_mul_f32 v3, s48, v3
    v_mfma_f32_16x16x32_bf16 v[4:7], a[196:199], a[40:43], v[4:7]
    v_exp_f32 v0, v0
    v_mfma_f32_16x16x32_bf16 v[4:7], a[200:203], a[44:47], v[4:7]
    ds_read_b128 a[88:91], v197 offset:12800
    v_mfma_f32_16x16x32_bf16 v[4:7], a[204:207], a[48:51], v[4:7]
    v_exp_f32 v1, v1
    v_mfma_f32_16x16x32_bf16 v[4:7], a[208:211], a[52:55], v[4:7]
    ds_read_b128 a[184:187], v197 offset:12864
    v_mfma_f32_16x16x32_bf16 v[4:7], a[212:215], a[56:59], v[4:7]
    v_exp_f32 v2, v2
    v_mfma_f32_16x16x32_bf16 v[4:7], a[216:219], a[60:63], v[4:7]
    ds_read_b128 a[92:95], v197 offset:13376
    s_waitcnt lgkmcnt(9)
    v_mfma_f32_16x16x32_bf16 v[4:7], a[220:223], a[64:67], v[4:7]
    v_exp_f32 v3, v3
    v_mfma_f32_16x16x32_bf16 v[4:7], v[210:213], a[100:103], v[4:7]
    ds_read_b128 a[188:191], v197 offset:13440
    v_add_f32 v0, 1.0, v0
    v_mfma_f32_16x16x32_bf16 v[4:7], v[214:217], a[104:107], v[4:7]
    v_add_f32 v1, 1.0, v1
    v_add_f32 v2, 1.0, v2
    v_mfma_f32_16x16x32_bf16 v[4:7], v[218:221], a[108:111], v[4:7]
    v_add_f32 v3, 1.0, v3
    v_mfma_f32_16x16x32_bf16 v[4:7], v[222:225], a[112:115], v[4:7]
    v_rcp_f32 v0, v0
    v_mfma_f32_16x16x32_bf16 v[4:7], v[226:229], a[116:119], v[4:7]
    v_rcp_f32 v1, v1
    v_mfma_f32_16x16x32_bf16 v[4:7], v[230:233], a[120:123], v[4:7]
    v_rcp_f32 v2, v2
    v_mfma_f32_16x16x32_bf16 v[4:7], v[234:237], a[124:127], v[4:7]
    v_rcp_f32 v3, v3
    v_mfma_f32_16x16x32_bf16 v[4:7], v[238:241], a[128:131], v[4:7]
    v_fma_f32 v0, v0, v199, s50
    v_fma_f32 v1, v1, v199, s50
    v_mfma_f32_16x16x32_bf16 v[4:7], v[108:111], a[132:135], v[4:7]
    v_fma_f32 v2, v2, v199, s50
    v_fma_f32 v3, v3, v199, s50
    v_mfma_f32_16x16x32_bf16 v[4:7], v[112:115], a[136:139], v[4:7]
    v_cvt_pk_bf16_f32 v0, v0, v1
    v_mfma_f32_16x16x32_bf16 v[4:7], v[116:119], a[140:143], v[4:7]
    v_cvt_pk_bf16_f32 v1, v2, v3
    v_mfma_f32_16x16x32_bf16 v[4:7], v[120:123], a[144:147], v[4:7]
    ds_write_b64 v200, v[0:1] offset:0
    v_mfma_f32_16x16x32_bf16 v[4:7], v[124:127], a[148:151], v[4:7]
    v_mfma_f32_16x16x32_bf16 v[4:7], v[128:131], a[152:155], v[4:7]
    v_mfma_f32_16x16x32_bf16 v[4:7], v[132:135], a[156:159], v[4:7]
    v_mfma_f32_16x16x32_bf16 v[4:7], v[136:139], a[160:163], v[4:7]
    v_mfma_f32_16x16x32_bf16 v[8:11], a[224:227], a[8:11], v[8:11]
    v_mfma_f32_16x16x32_bf16 v[8:11], a[228:231], a[12:15], v[8:11]
    v_mfma_f32_16x16x32_bf16 v[8:11], a[232:235], a[16:19], v[8:11]
    v_mfma_f32_16x16x32_bf16 v[8:11], a[236:239], a[20:23], v[8:11]
    v_mfma_f32_16x16x32_bf16 v[8:11], a[240:243], a[24:27], v[8:11]
    v_mfma_f32_16x16x32_bf16 v[8:11], a[244:247], a[28:31], v[8:11]
    s_nop 1
    v_mul_f32 v4, s48, v4
    v_mfma_f32_16x16x32_bf16 v[8:11], a[248:251], a[32:35], v[8:11]
    v_mul_f32 v5, s48, v5
    v_mfma_f32_16x16x32_bf16 v[8:11], a[252:255], a[36:39], v[8:11]
    v_mul_f32 v6, s48, v6
    v_mfma_f32_16x16x32_bf16 v[8:11], a[192:195], a[40:43], v[8:11]
    v_mul_f32 v7, s48, v7
    v_mfma_f32_16x16x32_bf16 v[8:11], a[196:199], a[44:47], v[8:11]
    v_exp_f32 v4, v4
    v_mfma_f32_16x16x32_bf16 v[8:11], a[200:203], a[48:51], v[8:11]
    v_exp_f32 v5, v5
    v_mfma_f32_16x16x32_bf16 v[8:11], a[204:207], a[52:55], v[8:11]
    v_exp_f32 v6, v6
    v_mfma_f32_16x16x32_bf16 v[8:11], a[208:211], a[56:59], v[8:11]
    v_exp_f32 v7, v7
    v_mfma_f32_16x16x32_bf16 v[8:11], a[212:215], a[60:63], v[8:11]
    v_add_f32 v4, 1.0, v4
    v_mfma_f32_16x16x32_bf16 v[8:11], a[216:219], a[64:67], v[8:11]
    v_add_f32 v5, 1.0, v5
    v_mfma_f32_16x16x32_bf16 v[8:11], a[220:223], a[68:71], v[8:11]
    v_add_f32 v6, 1.0, v6
    v_mfma_f32_16x16x32_bf16 v[8:11], v[210:213], a[104:107], v[8:11]
    v_add_f32 v7, 1.0, v7
    v_mfma_f32_16x16x32_bf16 v[8:11], v[214:217], a[108:111], v[8:11]
    v_rcp_f32 v4, v4
    v_mfma_f32_16x16x32_bf16 v[8:11], v[218:221], a[112:115], v[8:11]
    v_rcp_f32 v5, v5
    v_mfma_f32_16x16x32_bf16 v[8:11], v[222:225], a[116:119], v[8:11]
    v_rcp_f32 v6, v6
    v_mfma_f32_16x16x32_bf16 v[8:11], v[226:229], a[120:123], v[8:11]
    v_rcp_f32 v7, v7
    v_mfma_f32_16x16x32_bf16 v[8:11], v[230:233], a[124:127], v[8:11]
    v_fma_f32 v4, v4, v199, s50
    v_mfma_f32_16x16x32_bf16 v[8:11], v[234:237], a[128:131], v[8:11]
    v_fma_f32 v5, v5, v199, s50
    v_mfma_f32_16x16x32_bf16 v[8:11], v[238:241], a[132:135], v[8:11]
    v_fma_f32 v6, v6, v199, s50
    v_mfma_f32_16x16x32_bf16 v[8:11], v[108:111], a[136:139], v[8:11]
    v_fma_f32 v7, v7, v199, s50
    v_mfma_f32_16x16x32_bf16 v[8:11], v[112:115], a[140:143], v[8:11]
    v_cvt_pk_bf16_f32 v4, v4, v5
    v_mfma_f32_16x16x32_bf16 v[8:11], v[116:119], a[144:147], v[8:11]
    v_cvt_pk_bf16_f32 v5, v6, v7
    v_mfma_f32_16x16x32_bf16 v[8:11], v[120:123], a[148:151], v[8:11]
    ds_write_b64 v200, v[4:5] offset:2048
    v_mfma_f32_16x16x32_bf16 v[8:11], v[124:127], a[152:155], v[8:11]
    v_mfma_f32_16x16x32_bf16 v[8:11], v[128:131], a[156:159], v[8:11]
    v_mfma_f32_16x16x32_bf16 v[8:11], v[132:135], a[160:163], v[8:11]
    v_mfma_f32_16x16x32_bf16 v[8:11], v[136:139], a[164:167], v[8:11]
    v_mfma_f32_16x16x32_bf16 v[12:15], a[224:227], a[12:15], v[12:15]
    v_mfma_f32_16x16x32_bf16 v[12:15], a[228:231], a[16:19], v[12:15]
    v_mfma_f32_16x16x32_bf16 v[12:15], a[232:235], a[20:23], v[12:15]
    v_mfma_f32_16x16x32_bf16 v[12:15], a[236:239], a[24:27], v[12:15]
    v_mfma_f32_16x16x32_bf16 v[12:15], a[240:243], a[28:31], v[12:15]
    v_mfma_f32_16x16x32_bf16 v[12:15], a[244:247], a[32:35], v[12:15]
    s_nop 1
    v_mul_f32 v8, s48, v8
    v_mfma_f32_16x16x32_bf16 v[12:15], a[248:251], a[36:39], v[12:15]
    s_waitcnt lgkmcnt(0)
    s_barrier
    v_mfma_f32_16x16x32_bf16 v[12:15], a[252:255], a[40:43], v[12:15]
    ds_read_b64 v[156:157], v201 offset:0
    ds_read_b64 v[158:159], v201 offset:512
    v_mfma_f32_16x16x32_bf16 v[12:15], a[192:195], a[44:47], v[12:15]
    v_mul_f32 v9, s48, v9
    v_mul_f32 v10, s48, v10
    v_mfma_f32_16x16x32_bf16 v[12:15], a[196:199], a[48:51], v[12:15]
    v_mul_f32 v11, s48, v11
    v_mfma_f32_16x16x32_bf16 v[12:15], a[200:203], a[52:55], v[12:15]
    v_exp_f32 v8, v8
    v_mfma_f32_16x16x32_bf16 v[12:15], a[204:207], a[56:59], v[12:15]
    v_exp_f32 v9, v9
    v_mfma_f32_16x16x32_bf16 v[12:15], a[208:211], a[60:63], v[12:15]
    v_exp_f32 v10, v10
    v_mfma_f32_16x16x32_bf16 v[12:15], a[212:215], a[64:67], v[12:15]
    v_exp_f32 v11, v11
    v_mfma_f32_16x16x32_bf16 v[12:15], a[216:219], a[68:71], v[12:15]
    v_add_f32 v8, 1.0, v8
    v_add_f32 v9, 1.0, v9
    v_mfma_f32_16x16x32_bf16 v[12:15], a[220:223], a[72:75], v[12:15]
    v_add_f32 v10, 1.0, v10
    s_waitcnt lgkmcnt(1)
    v_lshlrev_b32 v160, 16, v156
    v_mfma_f32_16x16x32_bf16 v[12:15], v[210:213], a[108:111], v[12:15]
    v_add_f32 v11, 1.0, v11
    v_and_b32 v161, s41, v156
    v_mfma_f32_16x16x32_bf16 v[12:15], v[214:217], a[112:115], v[12:15]
    v_rcp_f32 v8, v8
    v_mfma_f32_16x16x32_bf16 v[12:15], v[218:221], a[116:119], v[12:15]
    v_rcp_f32 v9, v9
    v_mfma_f32_16x16x32_bf16 v[12:15], v[222:225], a[120:123], v[12:15]
    v_rcp_f32 v10, v10
    v_mfma_f32_16x16x32_bf16 v[12:15], v[226:229], a[124:127], v[12:15]
    v_rcp_f32 v11, v11
    v_mfma_f32_16x16x32_bf16 v[12:15], v[230:233], a[128:131], v[12:15]
    v_fma_f32 v8, v8, v199, s50
    s_waitcnt lgkmcnt(0)
    v_lshlrev_b32 v162, 16, v158
    v_mfma_f32_16x16x32_bf16 v[12:15], v[234:237], a[132:135], v[12:15]
    v_fma_f32 v9, v9, v199, s50
    v_and_b32 v163, s41, v158
    v_mfma_f32_16x16x32_bf16 v[12:15], v[238:241], a[136:139], v[12:15]
    v_fma_f32 v10, v10, v199, s50
    v_mul_f32 v160, v160, v162
    v_mfma_f32_16x16x32_bf16 v[12:15], v[108:111], a[140:143], v[12:15]
    v_fma_f32 v11, v11, v199, s50
    v_mul_f32 v161, v161, v163
    v_mfma_f32_16x16x32_bf16 v[12:15], v[112:115], a[144:147], v[12:15]
    v_cvt_pk_bf16_f32 v8, v8, v9
    v_cvt_pk_bf16_f32 v168, v160, v161
    v_mfma_f32_16x16x32_bf16 v[12:15], v[116:119], a[148:151], v[12:15]
    v_cvt_pk_bf16_f32 v9, v10, v11
    v_lshlrev_b32 v164, 16, v157
    v_mfma_f32_16x16x32_bf16 v[12:15], v[120:123], a[152:155], v[12:15]
    ds_write_b64 v200, v[8:9] offset:4096
    v_mfma_f32_16x16x32_bf16 v[12:15], v[124:127], a[156:159], v[12:15]
    v_and_b32 v165, s41, v157
    v_lshlrev_b32 v166, 16, v159
    v_mfma_f32_16x16x32_bf16 v[12:15], v[128:131], a[160:163], v[12:15]
    v_and_b32 v167, s41, v159
    v_mul_f32 v164, v164, v166
    v_mfma_f32_16x16x32_bf16 v[12:15], v[132:135], a[164:167], v[12:15]
    v_mul_f32 v165, v165, v167
    v_cvt_pk_bf16_f32 v169, v164, v165
    v_mfma_f32_16x16x32_bf16 v[12:15], v[136:139], a[168:171], v[12:15]
    buffer_store_dwordx2 v[168:169], v206, s[12:15], 0 offen
    v_mfma_f32_16x16x32_bf16 v[16:19], a[224:227], a[16:19], v[16:19]
    v_mfma_f32_16x16x32_bf16 v[16:19], a[228:231], a[20:23], v[16:19]
    v_mfma_f32_16x16x32_bf16 v[16:19], a[232:235], a[24:27], v[16:19]
    v_mfma_f32_16x16x32_bf16 v[16:19], a[236:239], a[28:31], v[16:19]
    v_mfma_f32_16x16x32_bf16 v[16:19], a[240:243], a[32:35], v[16:19]
    v_mfma_f32_16x16x32_bf16 v[16:19], a[244:247], a[36:39], v[16:19]
    s_nop 0
    v_mul_f32 v12, s48, v12
    v_mfma_f32_16x16x32_bf16 v[16:19], a[248:251], a[40:43], v[16:19]
    v_mul_f32 v13, s48, v13
    v_mfma_f32_16x16x32_bf16 v[16:19], a[252:255], a[44:47], v[16:19]
    v_mul_f32 v14, s48, v14
    v_mfma_f32_16x16x32_bf16 v[16:19], a[192:195], a[48:51], v[16:19]
    v_mul_f32 v15, s48, v15
    v_mfma_f32_16x16x32_bf16 v[16:19], a[196:199], a[52:55], v[16:19]
    v_exp_f32 v12, v12
    v_mfma_f32_16x16x32_bf16 v[16:19], a[200:203], a[56:59], v[16:19]
    v_exp_f32 v13, v13
    v_mfma_f32_16x16x32_bf16 v[16:19], a[204:207], a[60:63], v[16:19]
    v_exp_f32 v14, v14
    v_mfma_f32_16x16x32_bf16 v[16:19], a[208:211], a[64:67], v[16:19]
    v_exp_f32 v15, v15
    v_mfma_f32_16x16x32_bf16 v[16:19], a[212:215], a[68:71], v[16:19]
    v_add_f32 v12, 1.0, v12
    v_mfma_f32_16x16x32_bf16 v[16:19], a[216:219], a[72:75], v[16:19]
    v_add_f32 v13, 1.0, v13
    v_mfma_f32_16x16x32_bf16 v[16:19], a[220:223], a[76:79], v[16:19]
    v_add_f32 v14, 1.0, v14
    v_mfma_f32_16x16x32_bf16 v[16:19], v[210:213], a[112:115], v[16:19]
    v_add_f32 v15, 1.0, v15
    v_mfma_f32_16x16x32_bf16 v[16:19], v[214:217], a[116:119], v[16:19]
    v_rcp_f32 v12, v12
    v_mfma_f32_16x16x32_bf16 v[16:19], v[218:221], a[120:123], v[16:19]
    v_rcp_f32 v13, v13
    v_mfma_f32_16x16x32_bf16 v[16:19], v[222:225], a[124:127], v[16:19]
    v_rcp_f32 v14, v14
    v_mfma_f32_16x16x32_bf16 v[16:19], v[226:229], a[128:131], v[16:19]
    v_rcp_f32 v15, v15
    v_mfma_f32_16x16x32_bf16 v[16:19], v[230:233], a[132:135], v[16:19]
    v_fma_f32 v12, v12, v199, s50
    v_mfma_f32_16x16x32_bf16 v[16:19], v[234:237], a[136:139], v[16:19]
    v_fma_f32 v13, v13, v199, s50
    v_mfma_f32_16x16x32_bf16 v[16:19], v[238:241], a[140:143], v[16:19]
    v_fma_f32 v14, v14, v199, s50
    v_mfma_f32_16x16x32_bf16 v[16:19], v[108:111], a[144:147], v[16:19]
    v_fma_f32 v15, v15, v199, s50
    v_mfma_f32_16x16x32_bf16 v[16:19], v[112:115], a[148:151], v[16:19]
    v_cvt_pk_bf16_f32 v12, v12, v13
    v_mfma_f32_16x16x32_bf16 v[16:19], v[116:119], a[152:155], v[16:19]
    v_cvt_pk_bf16_f32 v13, v14, v15
    v_mfma_f32_16x16x32_bf16 v[16:19], v[120:123], a[156:159], v[16:19]
    ds_write_b64 v200, v[12:13] offset:6144
    v_mfma_f32_16x16x32_bf16 v[16:19], v[124:127], a[160:163], v[16:19]
    v_mfma_f32_16x16x32_bf16 v[16:19], v[128:131], a[164:167], v[16:19]
    v_mfma_f32_16x16x32_bf16 v[16:19], v[132:135], a[168:171], v[16:19]
    v_mfma_f32_16x16x32_bf16 v[16:19], v[136:139], a[172:175], v[16:19]
    v_mfma_f32_16x16x32_bf16 v[20:23], a[224:227], a[20:23], v[20:23]
    v_mfma_f32_16x16x32_bf16 v[20:23], a[228:231], a[24:27], v[20:23]
    v_mfma_f32_16x16x32_bf16 v[20:23], a[232:235], a[28:31], v[20:23]
    v_mfma_f32_16x16x32_bf16 v[20:23], a[236:239], a[32:35], v[20:23]
    v_mfma_f32_16x16x32_bf16 v[20:23], a[240:243], a[36:39], v[20:23]
    v_mfma_f32_16x16x32_bf16 v[20:23], a[244:247], a[40:43], v[20:23]
    s_nop 1
    v_mul_f32 v16, s48, v16
    v_mfma_f32_16x16x32_bf16 v[20:23], a[248:251], a[44:47], v[20:23]
    s_waitcnt lgkmcnt(0)
    s_barrier
    v_mfma_f32_16x16x32_bf16 v[20:23], a[252:255], a[48:51], v[20:23]
    ds_read_b64 v[156:157], v201 offset:4096
    ds_read_b64 v[158:159], v201 offset:4608
    v_mfma_f32_16x16x32_bf16 v[20:23], a[192:195], a[52:55], v[20:23]
    v_mul_f32 v17, s48, v17
    v_mul_f32 v18, s48, v18
    v_mfma_f32_16x16x32_bf16 v[20:23], a[196:199], a[56:59], v[20:23]
    v_mul_f32 v19, s48, v19
    v_mfma_f32_16x16x32_bf16 v[20:23], a[200:203], a[60:63], v[20:23]
    v_exp_f32 v16, v16
    v_mfma_f32_16x16x32_bf16 v[20:23], a[204:207], a[64:67], v[20:23]
    v_exp_f32 v17, v17
    v_mfma_f32_16x16x32_bf16 v[20:23], a[208:211], a[68:71], v[20:23]
    v_exp_f32 v18, v18
    v_mfma_f32_16x16x32_bf16 v[20:23], a[212:215], a[72:75], v[20:23]
    v_exp_f32 v19, v19
    v_mfma_f32_16x16x32_bf16 v[20:23], a[216:219], a[76:79], v[20:23]
    v_add_f32 v16, 1.0, v16
    v_add_f32 v17, 1.0, v17
    v_mfma_f32_16x16x32_bf16 v[20:23], a[220:223], a[80:83], v[20:23]
    v_add_f32 v18, 1.0, v18
    s_waitcnt lgkmcnt(1)
    v_lshlrev_b32 v160, 16, v156
    v_mfma_f32_16x16x32_bf16 v[20:23], v[210:213], a[116:119], v[20:23]
    v_add_f32 v19, 1.0, v19
    v_and_b32 v161, s41, v156
    v_mfma_f32_16x16x32_bf16 v[20:23], v[214:217], a[120:123], v[20:23]
    v_rcp_f32 v16, v16
    v_mfma_f32_16x16x32_bf16 v[20:23], v[218:221], a[124:127], v[20:23]
    v_rcp_f32 v17, v17
    v_mfma_f32_16x16x32_bf16 v[20:23], v[222:225], a[128:131], v[20:23]
    v_rcp_f32 v18, v18
    v_mfma_f32_16x16x32_bf16 v[20:23], v[226:229], a[132:135], v[20:23]
    v_rcp_f32 v19, v19
    v_mfma_f32_16x16x32_bf16 v[20:23], v[230:233], a[136:139], v[20:23]
    v_fma_f32 v16, v16, v199, s50
    s_waitcnt lgkmcnt(0)
    v_lshlrev_b32 v162, 16, v158
    v_mfma_f32_16x16x32_bf16 v[20:23], v[234:237], a[140:143], v[20:23]
    v_fma_f32 v17, v17, v199, s50
    v_and_b32 v163, s41, v158
    v_mfma_f32_16x16x32_bf16 v[20:23], v[238:241], a[144:147], v[20:23]
    v_fma_f32 v18, v18, v199, s50
    v_mul_f32 v160, v160, v162
    v_mfma_f32_16x16x32_bf16 v[20:23], v[108:111], a[148:151], v[20:23]
    v_fma_f32 v19, v19, v199, s50
    v_mul_f32 v161, v161, v163
    v_mfma_f32_16x16x32_bf16 v[20:23], v[112:115], a[152:155], v[20:23]
    v_cvt_pk_bf16_f32 v16, v16, v17
    v_cvt_pk_bf16_f32 v170, v160, v161
    v_mfma_f32_16x16x32_bf16 v[20:23], v[116:119], a[156:159], v[20:23]
    v_cvt_pk_bf16_f32 v17, v18, v19
    v_lshlrev_b32 v164, 16, v157
    v_mfma_f32_16x16x32_bf16 v[20:23], v[120:123], a[160:163], v[20:23]
    ds_write_b64 v200, v[16:17] offset:8192
    v_mfma_f32_16x16x32_bf16 v[20:23], v[124:127], a[164:167], v[20:23]
    v_and_b32 v165, s41, v157
    v_lshlrev_b32 v166, 16, v159
    v_mfma_f32_16x16x32_bf16 v[20:23], v[128:131], a[168:171], v[20:23]
    v_and_b32 v167, s41, v159
    v_mul_f32 v164, v164, v166
    v_mfma_f32_16x16x32_bf16 v[20:23], v[132:135], a[172:175], v[20:23]
    v_mul_f32 v165, v165, v167
    v_cvt_pk_bf16_f32 v171, v164, v165
    v_mfma_f32_16x16x32_bf16 v[20:23], v[136:139], a[176:179], v[20:23]
    buffer_store_dwordx2 v[170:171], v206, s[12:15], 0 offen offset:2304
    v_mfma_f32_16x16x32_bf16 v[24:27], a[224:227], a[24:27], v[24:27]
    v_mfma_f32_16x16x32_bf16 v[24:27], a[228:231], a[28:31], v[24:27]
    v_mfma_f32_16x16x32_bf16 v[24:27], a[232:235], a[32:35], v[24:27]
    v_mfma_f32_16x16x32_bf16 v[24:27], a[236:239], a[36:39], v[24:27]
    v_mfma_f32_16x16x32_bf16 v[24:27], a[240:243], a[40:43], v[24:27]
    v_mfma_f32_16x16x32_bf16 v[24:27], a[244:247], a[44:47], v[24:27]
    s_nop 0
    v_mul_f32 v20, s48, v20
    v_mfma_f32_16x16x32_bf16 v[24:27], a[248:251], a[48:51], v[24:27]
    v_mul_f32 v21, s48, v21
    v_mfma_f32_16x16x32_bf16 v[24:27], a[252:255], a[52:55], v[24:27]
    v_mul_f32 v22, s48, v22
    v_mfma_f32_16x16x32_bf16 v[24:27], a[192:195], a[56:59], v[24:27]
    v_mul_f32 v23, s48, v23
    v_mfma_f32_16x16x32_bf16 v[24:27], a[196:199], a[60:63], v[24:27]
    v_exp_f32 v20, v20
    v_mfma_f32_16x16x32_bf16 v[24:27], a[200:203], a[64:67], v[24:27]
    v_exp_f32 v21, v21
    v_mfma_f32_16x16x32_bf16 v[24:27], a[204:207], a[68:71], v[24:27]
    v_exp_f32 v22, v22
    v_mfma_f32_16x16x32_bf16 v[24:27], a[208:211], a[72:75], v[24:27]
    v_exp_f32 v23, v23
    v_mfma_f32_16x16x32_bf16 v[24:27], a[212:215], a[76:79], v[24:27]
    v_add_f32 v20, 1.0, v20
    v_mfma_f32_16x16x32_bf16 v[24:27], a[216:219], a[80:83], v[24:27]
    v_add_f32 v21, 1.0, v21
    v_mfma_f32_16x16x32_bf16 v[24:27], a[220:223], a[84:87], v[24:27]
    v_add_f32 v22, 1.0, v22
    v_mfma_f32_16x16x32_bf16 v[24:27], v[210:213], a[120:123], v[24:27]
    v_add_f32 v23, 1.0, v23
    v_mfma_f32_16x16x32_bf16 v[24:27], v[214:217], a[124:127], v[24:27]
    v_rcp_f32 v20, v20
    v_mfma_f32_16x16x32_bf16 v[24:27], v[218:221], a[128:131], v[24:27]
    v_rcp_f32 v21, v21
    v_mfma_f32_16x16x32_bf16 v[24:27], v[222:225], a[132:135], v[24:27]
    v_rcp_f32 v22, v22
    v_mfma_f32_16x16x32_bf16 v[24:27], v[226:229], a[136:139], v[24:27]
    v_rcp_f32 v23, v23
    v_mfma_f32_16x16x32_bf16 v[24:27], v[230:233], a[140:143], v[24:27]
    v_fma_f32 v20, v20, v199, s50
    v_mfma_f32_16x16x32_bf16 v[24:27], v[234:237], a[144:147], v[24:27]
    v_fma_f32 v21, v21, v199, s50
    v_mfma_f32_16x16x32_bf16 v[24:27], v[238:241], a[148:151], v[24:27]
    v_fma_f32 v22, v22, v199, s50
    v_mfma_f32_16x16x32_bf16 v[24:27], v[108:111], a[152:155], v[24:27]
    v_fma_f32 v23, v23, v199, s50
    v_mfma_f32_16x16x32_bf16 v[24:27], v[112:115], a[156:159], v[24:27]
    v_cvt_pk_bf16_f32 v20, v20, v21
    v_mfma_f32_16x16x32_bf16 v[24:27], v[116:119], a[160:163], v[24:27]
    v_cvt_pk_bf16_f32 v21, v22, v23
    v_mfma_f32_16x16x32_bf16 v[24:27], v[120:123], a[164:167], v[24:27]
    ds_write_b64 v200, v[20:21] offset:10240
    v_mfma_f32_16x16x32_bf16 v[24:27], v[124:127], a[168:171], v[24:27]
    v_mfma_f32_16x16x32_bf16 v[24:27], v[128:131], a[172:175], v[24:27]
    v_mfma_f32_16x16x32_bf16 v[24:27], v[132:135], a[176:179], v[24:27]
    v_mfma_f32_16x16x32_bf16 v[24:27], v[136:139], a[180:183], v[24:27]
    v_mfma_f32_16x16x32_bf16 v[28:31], a[224:227], a[28:31], v[28:31]
    v_mfma_f32_16x16x32_bf16 v[28:31], a[228:231], a[32:35], v[28:31]
    v_mfma_f32_16x16x32_bf16 v[28:31], a[232:235], a[36:39], v[28:31]
    v_mfma_f32_16x16x32_bf16 v[28:31], a[236:239], a[40:43], v[28:31]
    v_mfma_f32_16x16x32_bf16 v[28:31], a[240:243], a[44:47], v[28:31]
    v_mfma_f32_16x16x32_bf16 v[28:31], a[244:247], a[48:51], v[28:31]
    s_nop 1
    v_mul_f32 v24, s48, v24
    v_mfma_f32_16x16x32_bf16 v[28:31], a[248:251], a[52:55], v[28:31]
    s_waitcnt lgkmcnt(0)
    s_barrier
    v_mfma_f32_16x16x32_bf16 v[28:31], a[252:255], a[56:59], v[28:31]
    ds_read_b64 v[156:157], v201 offset:8192
    ds_read_b64 v[158:159], v201 offset:8704
    v_mfma_f32_16x16x32_bf16 v[28:31], a[192:195], a[60:63], v[28:31]
    v_mul_f32 v25, s48, v25
    v_mul_f32 v26, s48, v26
    v_mfma_f32_16x16x32_bf16 v[28:31], a[196:199], a[64:67], v[28:31]
    v_mul_f32 v27, s48, v27
    v_mfma_f32_16x16x32_bf16 v[28:31], a[200:203], a[68:71], v[28:31]
    v_exp_f32 v24, v24
    v_mfma_f32_16x16x32_bf16 v[28:31], a[204:207], a[72:75], v[28:31]
    v_exp_f32 v25, v25
    v_mfma_f32_16x16x32_bf16 v[28:31], a[208:211], a[76:79], v[28:31]
    v_exp_f32 v26, v26
    v_mfma_f32_16x16x32_bf16 v[28:31], a[212:215], a[80:83], v[28:31]
    v_exp_f32 v27, v27
    v_mfma_f32_16x16x32_bf16 v[28:31], a[216:219], a[84:87], v[28:31]
    v_add_f32 v24, 1.0, v24
    v_add_f32 v25, 1.0, v25
    v_mfma_f32_16x16x32_bf16 v[28:31], a[220:223], a[88:91], v[28:31]
    v_add_f32 v26, 1.0, v26
    s_waitcnt lgkmcnt(1)
    v_lshlrev_b32 v160, 16, v156
    v_mfma_f32_16x16x32_bf16 v[28:31], v[210:213], a[124:127], v[28:31]
    v_add_f32 v27, 1.0, v27
    v_and_b32 v161, s41, v156
    v_mfma_f32_16x16x32_bf16 v[28:31], v[214:217], a[128:131], v[28:31]
    v_rcp_f32 v24, v24
    v_mfma_f32_16x16x32_bf16 v[28:31], v[218:221], a[132:135], v[28:31]
    v_rcp_f32 v25, v25
    v_mfma_f32_16x16x32_bf16 v[28:31], v[222:225], a[136:139], v[28:31]
    v_rcp_f32 v26, v26
    v_mfma_f32_16x16x32_bf16 v[28:31], v[226:229], a[140:143], v[28:31]
    v_rcp_f32 v27, v27
    v_mfma_f32_16x16x32_bf16 v[28:31], v[230:233], a[144:147], v[28:31]
    v_fma_f32 v24, v24, v199, s50
    s_waitcnt lgkmcnt(0)
    v_lshlrev_b32 v162, 16, v158
    v_mfma_f32_16x16x32_bf16 v[28:31], v[234:237], a[148:151], v[28:31]
    v_fma_f32 v25, v25, v199, s50
    v_and_b32 v163, s41, v158
    v_mfma_f32_16x16x32_bf16 v[28:31], v[238:241], a[152:155], v[28:31]
    v_fma_f32 v26, v26, v199, s50
    v_mul_f32 v160, v160, v162
    v_mfma_f32_16x16x32_bf16 v[28:31], v[108:111], a[156:159], v[28:31]
    v_fma_f32 v27, v27, v199, s50
    v_mul_f32 v161, v161, v163
    v_mfma_f32_16x16x32_bf16 v[28:31], v[112:115], a[160:163], v[28:31]
    v_cvt_pk_bf16_f32 v24, v24, v25
    v_cvt_pk_bf16_f32 v168, v160, v161
    v_mfma_f32_16x16x32_bf16 v[28:31], v[116:119], a[164:167], v[28:31]
    v_cvt_pk_bf16_f32 v25, v26, v27
    v_lshlrev_b32 v164, 16, v157
    v_mfma_f32_16x16x32_bf16 v[28:31], v[120:123], a[168:171], v[28:31]
    ds_write_b64 v200, v[24:25] offset:0
    v_mfma_f32_16x16x32_bf16 v[28:31], v[124:127], a[172:175], v[28:31]
    v_and_b32 v165, s41, v157
    v_lshlrev_b32 v166, 16, v159
    v_mfma_f32_16x16x32_bf16 v[28:31], v[128:131], a[176:179], v[28:31]
    v_and_b32 v167, s41, v159
    v_mul_f32 v164, v164, v166
    v_mfma_f32_16x16x32_bf16 v[28:31], v[132:135], a[180:183], v[28:31]
    v_mul_f32 v165, v165, v167
    v_cvt_pk_bf16_f32 v169, v164, v165
    v_mfma_f32_16x16x32_bf16 v[28:31], v[136:139], a[184:187], v[28:31]
    buffer_store_dwordx2 v[168:169], v206, s[12:15], s60 offen
    v_mfma_f32_16x16x32_bf16 v[32:35], a[224:227], a[32:35], v[32:35]
    v_mfma_f32_16x16x32_bf16 v[32:35], a[228:231], a[36:39], v[32:35]
    v_mfma_f32_16x16x32_bf16 v[32:35], a[232:235], a[40:43], v[32:35]
    v_mfma_f32_16x16x32_bf16 v[32:35], a[236:239], a[44:47], v[32:35]
    s_nop 2
    v_mul_f32 v28, s48, v28
    v_mul_f32 v29, s48, v29
    v_mfma_f32_16x16x32_bf16 v[32:35], a[240:243], a[48:51], v[32:35]
    v_mul_f32 v30, s48, v30
    v_mul_f32 v31, s48, v31
    v_mfma_f32_16x16x32_bf16 v[32:35], a[244:247], a[52:55], v[32:35]
    v_exp_f32 v28, v28
    v_mfma_f32_16x16x32_bf16 v[32:35], a[248:251], a[56:59], v[32:35]
    v_exp_f32 v29, v29
    v_mfma_f32_16x16x32_bf16 v[32:35], a[252:255], a[60:63], v[32:35]
    v_exp_f32 v30, v30
    v_mfma_f32_16x16x32_bf16 v[32:35], a[192:195], a[64:67], v[32:35]
    v_exp_f32 v31, v31
    v_mfma_f32_16x16x32_bf16 v[32:35], a[196:199], a[68:71], v[32:35]
    v_add_f32 v28, 1.0, v28
    v_add_f32 v29, 1.0, v29
    v_mfma_f32_16x16x32_bf16 v[32:35], a[200:203], a[72:75], v[32:35]
    v_add_f32 v30, 1.0, v30
    v_add_f32 v31, 1.0, v31
    v_mfma_f32_16x16x32_bf16 v[32:35], a[204:207], a[76:79], v[32:35]
    v_rcp_f32 v28, v28
    v_mfma_f32_16x16x32_bf16 v[32:35], a[208:211], a[80:83], v[32:35]
    v_rcp_f32 v29, v29
    v_mfma_f32_16x16x32_bf16 v[32:35], a[212:215], a[84:87], v[32:35]
    v_rcp_f32 v30, v30
    v_mfma_f32_16x16x32_bf16 v[32:35], a[216:219], a[88:91], v[32:35]
    v_rcp_f32 v31, v31
    v_mfma_f32_16x16x32_bf16 v[32:35], a[220:223], a[92:95], v[32:35]
    v_fma_f32 v28, v28, v199, s50
    v_fma_f32 v29, v29, v199, s50
    v_mfma_f32_16x16x32_bf16 v[32:35], v[210:213], a[128:131], v[32:35]
    v_fma_f32 v30, v30, v199, s50
    v_fma_f32 v31, v31, v199, s50
    v_mfma_f32_16x16x32_bf16 v[32:35], v[214:217], a[132:135], v[32:35]
    v_cvt_pk_bf16_f32 v28, v28, v29
    v_cvt_pk_bf16_f32 v29, v30, v31
    v_mfma_f32_16x16x32_bf16 v[32:35], v[218:221], a[136:139], v[32:35]
    ds_write_b64 v200, v[28:29] offset:2048
    v_mfma_f32_16x16x32_bf16 v[32:35], v[222:225], a[140:143], v[32:35]
    v_mfma_f32_16x16x32_bf16 v[32:35], v[226:229], a[144:147], v[32:35]
    v_mfma_f32_16x16x32_bf16 v[32:35], v[230:233], a[148:151], v[32:35]
    v_mfma_f32_16x16x32_bf16 v[32:35], v[234:237], a[152:155], v[32:35]
    s_waitcnt lgkmcnt(0)
    s_barrier
    v_mfma_f32_16x16x32_bf16 v[32:35], v[238:241], a[156:159], v[32:35]
    ds_read_b64 v[156:157], v201 offset:0
    ds_read_b64 v[158:159], v201 offset:512
    v_mfma_f32_16x16x32_bf16 v[32:35], v[108:111], a[160:163], v[32:35]
    v_mfma_f32_16x16x32_bf16 v[32:35], v[112:115], a[164:167], v[32:35]
    v_mfma_f32_16x16x32_bf16 v[32:35], v[116:119], a[168:171], v[32:35]
    s_waitcnt lgkmcnt(1)
    v_lshlrev_b32 v160, 16, v156
    v_and_b32 v161, s41, v156
    v_mfma_f32_16x16x32_bf16 v[32:35], v[120:123], a[172:175], v[32:35]
    s_waitcnt lgkmcnt(0)
    v_lshlrev_b32 v162, 16, v158
    v_and_b32 v163, s41, v158
    v_mfma_f32_16x16x32_bf16 v[32:35], v[124:127], a[176:179], v[32:35]
    v_mul_f32 v160, v160, v162
    v_mul_f32 v161, v161, v163
    v_mfma_f32_16x16x32_bf16 v[32:35], v[128:131], a[180:183], v[32:35]
    v_cvt_pk_bf16_f32 v170, v160, v161
    v_lshlrev_b32 v164, 16, v157
    v_mfma_f32_16x16x32_bf16 v[32:35], v[132:135], a[184:187], v[32:35]
    v_and_b32 v165, s41, v157
    v_lshlrev_b32 v166, 16, v159
    v_mfma_f32_16x16x32_bf16 v[32:35], v[136:139], a[188:191], v[32:35]
    v_and_b32 v167, s41, v159
    v_mul_f32 v164, v164, v166
    v_mul_f32 v165, v165, v167
    v_cvt_pk_bf16_f32 v171, v164, v165
    buffer_store_dwordx2 v[170:171], v206, s[12:15], s46 offen
    s_nop 2
    v_mul_f32 v32, s48, v32
    v_mul_f32 v33, s48, v33
    v_mul_f32 v34, s48, v34
    v_mul_f32 v35, s48, v35
    v_exp_f32 v32, v32
    v_exp_f32 v33, v33
    v_exp_f32 v34, v34
    v_exp_f32 v35, v35
    v_add_f32 v32, 1.0, v32
    v_add_f32 v33, 1.0, v33
    v_add_f32 v34, 1.0, v34
    v_add_f32 v35, 1.0, v35
    v_rcp_f32 v32, v32
    v_rcp_f32 v33, v33
    v_rcp_f32 v34, v34
    v_rcp_f32 v35, v35
    v_fma_f32 v32, v32, v199, s50
    v_fma_f32 v33, v33, v199, s50
    v_fma_f32 v34, v34, v199, s50
    v_fma_f32 v35, v35, v199, s50
    v_cvt_pk_bf16_f32 v32, v32, v33
    v_cvt_pk_bf16_f32 v33, v34, v35
    ds_write_b64 v200, v[32:33] offset:4096
    s_waitcnt lgkmcnt(0)
    s_barrier
    ds_read_b64 v[156:157], v204 offset:4096
    ds_read_b64 v[158:159], v204 offset:4608
    s_waitcnt lgkmcnt(1)
    v_lshlrev_b32 v160, 16, v156
    v_and_b32 v161, s41, v156
    s_waitcnt lgkmcnt(0)
    v_lshlrev_b32 v162, 16, v158
    v_and_b32 v163, s41, v158
    v_mul_f32 v160, v160, v162
    v_mul_f32 v161, v161, v163
    v_cvt_pk_bf16_f32 v168, v160, v161
    v_lshlrev_b32 v164, 16, v157
    v_and_b32 v165, s41, v157
    v_lshlrev_b32 v166, 16, v159
    v_and_b32 v167, s41, v159
    v_mul_f32 v164, v164, v166
    v_mul_f32 v165, v165, v167
    v_cvt_pk_bf16_f32 v169, v164, v165
    s_mov_b64 exec, s[44:45]
    buffer_store_dwordx2 v[168:169], v206, s[12:15], s47 offen
L_end:
    s_endpgm
L_nspin:
    s_mov_b32 s3, 0x40000
L_nloop:
    buffer_load_dwordx2 v[202:203], v209, s[20:23], 0 offen sc1
    s_waitcnt vmcnt(0)
    v_readfirstlane_b32 s98, v202
    v_readfirstlane_b32 s99, v203
    s_nop 4
    s_cmp_lg_u64 s[98:99], 0
    s_cbranch_scc1 L_ngot
    s_sub_u32 s3, s3, 1
    s_cmp_lg_u32 s3, 0
    s_cbranch_scc1 L_nloop
L_ngot:
L_restamp:
    s_waitcnt vmcnt(0)
    v_mov_b32 v244, s98
    v_mov_b32 v245, s99
    s_mov_b64 exec, 1
    buffer_store_dwordx2 v[244:245], v209, s[16:19], s62 offen sc1
    s_mov_b64 exec, -1
    s_branch L_rback
L_f1spin:
    s_mov_b32 s3, 0x40000
L_f1loop:
    buffer_load_dwordx2 v[202:203], v208, s[16:19], 0 offen sc1
    s_waitcnt vmcnt(0)
    v_cmp_le_u64 vcc, s[98:99], v[202:203]
    v_cmp_gt_u64 s[36:37], s[100:101], v[202:203]
    s_nop 4
    s_and_b64 vcc, vcc, s[36:37]
    s_cmp_eq_u64 vcc, exec
    s_cbranch_scc1 L_f1back
    s_sub_u32 s3, s3, 1
    s_cmp_lg_u32 s3, 0
    s_cbranch_scc1 L_f1loop
    s_branch L_f1back
L_f2spin:
    s_mov_b32 s3, 0x40000
L_f2loop:
    buffer_load_dwordx2 v[202:203], v208, s[16:19], 0 offen sc1
    s_waitcnt vmcnt(0)
    v_cmp_le_u64 vcc, s[98:99], v[202:203]
    v_cmp_gt_u64 s[36:37], s[100:101], v[202:203]
    s_nop 4
    s_and_b64 vcc, vcc, s[36:37]
    s_cmp_eq_u64 vcc, exec
    s_cbranch_scc1 L_f2back
    s_sub_u32 s3, s3, 1
    s_cmp_lg_u32 s3, 0
    s_cbranch_scc1 L_f2loop
    s_branch L_f2back
L_f3spin:
    s_mov_b32 s3, 0x40000
L_f3loop:
    buffer_load_dwordx2 v[202:203], v208, s[16:19], 0 offen sc1
    s_waitcnt vmcnt(0)
    v_cmp_le_u64 vcc, s[98:99], v[202:203]
    v_cmp_gt_u64 s[36:37], s[100:101], v[202:203]
    s_nop 4
    s_and_b64 vcc, vcc, s[36:37]
    s_cmp_eq_u64 vcc, exec
    s_cbranch_scc1 L_f3back
    s_sub_u32 s3, s3, 1
    s_cmp_lg_u32 s3, 0
    s_cbranch_scc1 L_f3loop
    s_branch L_f3back
L_codeend:
.section .rodata,"a"
.p2align 6
.amdhsa_kernel standalone__autoregressive_conv_wavernn__speech_kernel
  .amdhsa_next_free_vgpr 512
  .amdhsa_next_free_sgpr 102
  .amdhsa_accum_offset 256
  .amdhsa_group_segment_fixed_size 0
  .amdhsa_kernarg_size 40
  .amdhsa_user_sgpr_count 2
  .amdhsa_user_sgpr_kernarg_segment_ptr 1
  .amdhsa_system_sgpr_workgroup_id_x 1
  .amdhsa_float_denorm_mode_32 3
.end_amdhsa_kernel
```
